```python
import torch

def _softmax(x, axis=-1):
    return torch.softmax(x, dim=axis)
def _gelu(x):
    return torch.nn.functional.gelu(x, approximate="tanh")
def _silu(x):
    return torch.nn.functional.silu(x)
def _sigmoid(x):
    return torch.sigmoid(x)
def _layernorm(x, axis=-1, eps=1e-5):
    m = x.mean(dim=axis, keepdim=True)
    v = x.var(dim=axis, keepdim=True, unbiased=False)
    return (x - m) / torch.sqrt(v + eps)
def _scatter_add(tgt, idx, src, axis=0):
    return tgt.clone().index_add_(axis, idx, src)
def _segment_sum(src, seg, n):
    out = torch.zeros((n,) + src.shape[1:], dtype=src.dtype)
    return out.index_add_(0, seg, src)
def _pad(x, pw):
    flat = tuple(v for pair in reversed(pw) for v in pair)
    return torch.nn.functional.pad(x, flat)

kernel_name = 'gated_mix__sliding_local_dilated__linear_kernel_hedgehog__prompt'

def setup_inputs():

    _w = (lambda a: (lambda t: t.to(torch.bfloat16) if t.is_floating_point() else t)(torch.as_tensor(a)))
    def _A_setup():
        B, S, D = 1, 2048, 448
        return {
            "x": _w((lambda *s: torch.randn(*s, dtype=torch.bfloat16) * 0.05)(B, S, D)),
            "wqkv": _w((lambda *s: torch.randn(*s, dtype=torch.bfloat16) * 0.8)(D, 3 * D)),
            "wo": _w((lambda *s: torch.randn(*s, dtype=torch.bfloat16) * 0.05)(D, D)),
        }
    _A_in = _A_setup()

    def _B_setup():
        B, S, D, H = 1, 2048, 448, 16
        Dh = D // H
        return {
            "x": _w((lambda *s: torch.randn(*s, dtype=torch.bfloat16) * 0.05)(B, S, D)),
            "wqkv": _w((lambda *s: torch.randn(*s, dtype=torch.bfloat16) * 1.6)(D, 3 * D)),
            "w_phi": _w((lambda *s: torch.randn(*s, dtype=torch.bfloat16) * 1.6)(H, Dh, Dh) * (Dh ** -0.5)),
            "wo": _w((lambda *s: torch.randn(*s, dtype=torch.bfloat16) * 0.2)(D, D)),
        }
    _B_in = _B_setup()

    return {
        "A_x": _A_in["x"],
        "A_wqkv": _A_in["wqkv"],
        "A_wo": _A_in["wo"],
        "B_x": _B_in["x"],
        "B_wqkv": _B_in["wqkv"],
        "B_w_phi": _B_in["w_phi"],
        "B_wo": _B_in["wo"],
        "gate_w": _w((lambda *s: torch.randn(*s, dtype=torch.bfloat16) * 0.05)(448) * 16.0),
    }

def reference(A_x, A_wqkv, A_wo, B_x, B_wqkv, B_w_phi, B_wo, gate_w):
    def _A_ref(x, wqkv, wo):
        B, S, D = x.shape
        H = 16; Dh = D // H
        W, dil = 8, 2
        qkv = (lambda x, *d: x.permute(*d))((x @ wqkv).reshape(B, S, 3, H, Dh), 2, 0, 3, 1, 4)
        q, k, v = qkv[0], qkv[1], qkv[2]
        scale = Dh ** -0.5
        pos = torch.arange(S)
        off = torch.arange(W) * dil
        idx = pos[:, None] - off[None, :]
        mask = idx >= 0
        idx_c = torch.where(mask, idx, 0).reshape(-1)
        kg = k[:, :, idx_c, :].reshape(B, H, S, W, Dh)
        vg = v[:, :, idx_c, :].reshape(B, H, S, W, Dh)
        logits = torch.einsum("bhsd,bhswd->bhsw", q, kg) * scale
        logits = torch.where(mask[None, None, :, :], logits, -1e9)
        attn = _softmax(logits, axis=-1)
        o = torch.einsum("bhsw,bhswd->bhsd", attn, vg)
        return (lambda x, *d: x.permute(*d))(o, 0, 2, 1, 3).reshape(B, S, D) @ wo

    def _B_ref(x, wqkv, w_phi, wo):
        B, S, D = x.shape
        H = 16; Dh = D // H
        qkv = (lambda x, *d: x.permute(*d))((x @ wqkv).reshape(B, S, 3, H, Dh), 2, 0, 3, 1, 4)
        q, k, v = qkv[0], qkv[1], qkv[2]
        pq = torch.einsum("bhsd,hdf->bhsf", q, w_phi)
        pk = torch.einsum("bhsd,hdf->bhsf", k, w_phi)
        phi_q = torch.concatenate([_softmax(pq, axis=-1), _softmax(-pq, axis=-1)], axis=-1)
        phi_k = torch.concatenate([_softmax(pk, axis=-1), _softmax(-pk, axis=-1)], axis=-1)
        kv = torch.einsum("bhsf,bhsd->bhfd", phi_k, v)
        z  = torch.einsum("bhsf->bhf", phi_k)
        num = torch.einsum("bhqf,bhfd->bhqd", phi_q, kv)
        den = torch.einsum("bhqf,bhf->bhq", phi_q, z)[..., None] + 1e-6
        o = num / den
        return (lambda x, *d: x.permute(*d))(o, 0, 2, 1, 3).reshape(B, S, D) @ wo

    x = A_x
    g = _sigmoid((x * gate_w).sum(-1, keepdims=True))
    a = _A_ref(x, A_wqkv, A_wo)
    b = _B_ref(x, B_wqkv, B_w_phi, B_wo)
    return g * a + (1 - g) * b
```

```asm
; @launch grid=(256,1,1) block=(512,1,1) lds=163840
.amdgcn_target "amdgcn-amd-amdhsa--gfx950"
.text
.globl gated_mix__sliding_local_dilated__linear_kernel_hedgehog__prompt_kernel
.p2align 8
.type gated_mix__sliding_local_dilated__linear_kernel_hedgehog__prompt_kernel,@function
gated_mix__sliding_local_dilated__linear_kernel_hedgehog__prompt_kernel:
    s_cmp_ge_u32 s2, 256
    s_cbranch_scc1 L_EXIT
    s_load_dwordx8 s[36:43], s[0:1], 0
    s_load_dwordx8 s[56:63], s[0:1], 32
    s_load_dwordx4 s[64:67], s[0:1], 64
    s_load_dwordx2 s[44:45], s[0:1], 80
    v_lshrrev_b32 v1, 6, v0
    v_and_b32 v0, 63, v0
    v_readfirstlane_b32 s35, v1
    s_and_b32 s3, s2, 7
    s_lshr_b32 s7, s2, 3
    s_and_b32 s7, s7, 15
    s_lshr_b32 s34, s2, 7
    s_and_b32 s5, s3, 3
    s_lshl_b32 s5, s5, 2
    s_and_b32 s6, s7, 3
    s_add_u32 s32, s5, s6
    s_lshr_b32 s5, s3, 2
    s_lshl_b32 s5, s5, 2
    s_lshr_b32 s6, s7, 2
    s_add_u32 s33, s5, s6
    s_mov_b32 s5, s32
    s_mul_i32 s6, s5, 37
    s_lshr_b32 s6, s6, 8
    s_mul_i32 s6, s6, 7
    s_sub_u32 s48, s5, s6
    s_mul_i32 s5, s7, 37
    s_lshr_b32 s5, s5, 8
    s_mul_i32 s6, s5, 7
    s_sub_u32 s47, s7, s6
    s_lshl_b32 s3, s3, 1
    s_add_u32 s46, s3, s5
    s_and_b32 s50, s35, 1
    s_lshr_b32 s51, s35, 1
    s_and_b32 s51, s51, 1
    s_lshr_b32 s52, s35, 2
    v_lshrrev_b32 v3, 3, v0
    v_and_b32 v4, 7, v0
    v_lshrrev_b32 v5, 1, v3
    v_xor_b32 v16, v4, v5
    v_lshlrev_b32 v16, 4, v16
    v_mul_u32_u24 v6, 1792, v3
    v_xor_b32 v17, 64, v16
    v_add_u32 v16, v16, v6
    v_add_u32 v17, v17, v6
    v_add_u32 v17, 14336, v17
    v_add_u32 v18, 28672, v16
    v_add_u32 v19, 28672, v17
    v_and_b32 v7, 1, v5
    v_lshlrev_b32 v7, 1, v7
    v_xor_b32 v20, v4, v7
    v_xor_b32 v21, 4, v20
    v_min_u32 v20, 6, v20
    v_min_u32 v21, 6, v21
    v_lshlrev_b32 v20, 4, v20
    v_lshlrev_b32 v21, 4, v21
    s_and_b32 s54, s35, 3
    s_lshl_b32 s53, s54, 4
    v_add_u32 v7, s53, v3
    v_mul_u32_u24 v7, 2688, v7
    v_add_u32 v20, v20, v7
    v_add_u32 v21, v21, v7
    v_add_u32 v21, 21504, v21
    s_lshl_b32 s53, s50, 1
    s_add_u32 s53, s53, 4
    v_add_u32 v22, s53, v5
    v_xor_b32 v22, v4, v22
    v_lshlrev_b32 v22, 4, v22
    v_add_u32 v22, v22, v6
    s_lshl_b32 s53, s50, 2
    s_add_u32 s53, s53, 8
    s_mul_i32 s53, s53, 1792
    v_add_u32 v22, s53, v22
    s_lshl_b32 s55, s32, 7
    s_max_u32 s86, s55, 32
    s_sub_u32 s86, s86, 32
    s_add_u32 s86, s86, s51
    s_mul_i32 s86, s86, 896
    s_lshl_b32 s53, s50, 6
    s_add_u32 s55, s55, s53
    s_add_u32 s55, s55, s51
    s_mul_i32 s55, s55, 896
    s_mul_i32 s87, s33, 112
    v_and_b32 v1, 15, v0
    v_lshrrev_b32 v2, 4, v0
    v_lshlrev_b32 v11, 4, v0
    s_waitcnt lgkmcnt(0)
    s_mov_b32 s8, s36
    s_and_b32 s9, s37, 0xffff
    s_mov_b32 s10, 1835008
    s_mov_b32 s11, 0x00020000
    s_mov_b32 s12, s38
    s_and_b32 s13, s39, 0xffff
    s_mov_b32 s14, 1204224
    s_mov_b32 s15, 0x00020000
    s_mov_b32 s92, s56
    s_and_b32 s93, s57, 0xffff
    s_mov_b32 s94, 1204224
    s_mov_b32 s95, 0x00020000
    s_mov_b32 s16, s44
    s_and_b32 s17, s45, 0xffff
    s_mov_b32 s18, 8388608
    s_mov_b32 s19, 0x00020000
    s_mov_b32 s20, s58
    s_and_b32 s21, s59, 0xffff
    s_mov_b32 s22, 25088
    s_mov_b32 s23, 0x00020000
    s_mov_b32 s24, s62
    s_and_b32 s25, s63, 0xffff
    s_mov_b32 s26, 896
    s_mov_b32 s27, 0x00020000
    s_mov_b32 s28, s66
    s_and_b32 s29, s67, 0xffff
    s_mov_b32 s30, 256
    s_mov_b32 s31, 0x00020000
    s_mov_b32 s72, s40
    s_and_b32 s73, s41, 0xffff
    s_mov_b32 s74, 401408
    s_mov_b32 s75, 0x00020000
    s_mov_b32 s76, s60
    s_and_b32 s77, s61, 0xffff
    s_mov_b32 s78, 401408
    s_mov_b32 s79, 0x00020000
    s_mov_b32 s80, s64
    s_and_b32 s81, s65, 0xffff
    s_mov_b32 s82, 1835008
    s_mov_b32 s83, 0x00020000
    s_mov_b32 s45, s7
    s_mov_b32 s60, s48
    s_cmp_eq_u32 s34, 1
    s_cbranch_scc1 L_KV
    s_cmp_eq_u32 s52, 0
    s_cbranch_scc1 L_AQ_COMP
    s_mul_i32 s58, s51, 9216
    s_lshl_b32 s71, s50, 9
    s_add_u32 s71, s71, s58
    s_lshl_b32 s53, s50, 12
    s_add_u32 s58, s58, s53
    s_add_u32 s58, s58, 1024
    s_and_b32 s59, s35, 3
    s_lshl_b32 s59, s59, 11
    s_add_u32 s59, s59, 18432
    s_mov_b32 s68, 51200
    s_mov_b32 s69, 153600
    s_mov_b32 s61, 0
    s_lshl_b32 s62, s60, 7
    s_add_u32 s63, s62, s86
    s_add_u32 s62, s62, s55
    s_mul_i32 s64, s60, 172032
    s_add_u32 s64, s64, s87
    s_add_u32 s60, s60, 1
    s_cmp_eq_u32 s60, 7
    s_cselect_b32 s60, 0, s60
    s_add_u32 s65, s58, s61
    s_add_u32 s56, s59, s61
    s_add_u32 m0, s65, 0
    s_nop 0
    buffer_load_dwordx4 v16, s[8:11], s62 offen lds
    s_add_u32 m0, s65, 1024
    s_nop 0
    buffer_load_dwordx4 v17, s[8:11], s62 offen lds
    s_add_u32 m0, s65, 2048
    s_nop 0
    buffer_load_dwordx4 v18, s[8:11], s62 offen lds
    s_add_u32 m0, s65, 3072
    s_nop 0
    buffer_load_dwordx4 v19, s[8:11], s62 offen lds
    s_add_u32 m0, s71, s61
    s_mov_b32 exec_hi, 0
    buffer_load_dwordx4 v22, s[8:11], s63 offen lds
    s_mov_b32 exec_hi, -1
    s_add_u32 m0, s56, 0
    s_nop 0
    buffer_load_dwordx4 v20, s[92:95], s64 offen lds
    s_add_u32 m0, s56, 1024
    s_nop 0
    buffer_load_dwordx4 v21, s[92:95], s64 offen lds
    s_add_u32 m0, s56, 8192
    s_nop 0
    buffer_load_dwordx4 v20, s[12:15], s64 offen lds
    s_add_u32 m0, s56, 9216
    s_nop 0
    buffer_load_dwordx4 v21, s[12:15], s64 offen lds
    s_add_u32 s66, s64, 896
    s_add_u32 m0, s56, 16384
    s_nop 0
    buffer_load_dwordx4 v20, s[12:15], s66 offen lds
    s_add_u32 m0, s56, 17408
    s_nop 0
    buffer_load_dwordx4 v21, s[12:15], s66 offen lds
    s_add_u32 s66, s64, 1792
    s_add_u32 m0, s56, 24576
    s_nop 0
    buffer_load_dwordx4 v20, s[12:15], s66 offen lds
    s_add_u32 m0, s56, 25600
    s_nop 0
    buffer_load_dwordx4 v21, s[12:15], s66 offen lds
    s_add_u32 s61, s61, s68
    s_cmp_eq_u32 s61, s69
    s_cselect_b32 s61, 0, s61
    s_lshl_b32 s62, s60, 7
    s_add_u32 s63, s62, s86
    s_add_u32 s62, s62, s55
    s_mul_i32 s64, s60, 172032
    s_add_u32 s64, s64, s87
    s_add_u32 s60, s60, 1
    s_cmp_eq_u32 s60, 7
    s_cselect_b32 s60, 0, s60
    s_add_u32 s65, s58, s61
    s_add_u32 s56, s59, s61
    s_add_u32 m0, s65, 0
    s_nop 0
    buffer_load_dwordx4 v16, s[8:11], s62 offen lds
    s_add_u32 m0, s65, 1024
    s_nop 0
    buffer_load_dwordx4 v17, s[8:11], s62 offen lds
    s_add_u32 m0, s65, 2048
    s_nop 0
    buffer_load_dwordx4 v18, s[8:11], s62 offen lds
    s_add_u32 m0, s65, 3072
    s_nop 0
    buffer_load_dwordx4 v19, s[8:11], s62 offen lds
    s_add_u32 m0, s71, s61
    s_mov_b32 exec_hi, 0
    buffer_load_dwordx4 v22, s[8:11], s63 offen lds
    s_mov_b32 exec_hi, -1
    s_add_u32 m0, s56, 0
    s_nop 0
    buffer_load_dwordx4 v20, s[92:95], s64 offen lds
    s_add_u32 m0, s56, 1024
    s_nop 0
    buffer_load_dwordx4 v21, s[92:95], s64 offen lds
    s_add_u32 m0, s56, 8192
    s_nop 0
    buffer_load_dwordx4 v20, s[12:15], s64 offen lds
    s_add_u32 m0, s56, 9216
    s_nop 0
    buffer_load_dwordx4 v21, s[12:15], s64 offen lds
    s_add_u32 s66, s64, 896
    s_add_u32 m0, s56, 16384
    s_nop 0
    buffer_load_dwordx4 v20, s[12:15], s66 offen lds
    s_add_u32 m0, s56, 17408
    s_nop 0
    buffer_load_dwordx4 v21, s[12:15], s66 offen lds
    s_add_u32 s66, s64, 1792
    s_add_u32 m0, s56, 24576
    s_nop 0
    buffer_load_dwordx4 v20, s[12:15], s66 offen lds
    s_add_u32 m0, s56, 25600
    s_nop 0
    buffer_load_dwordx4 v21, s[12:15], s66 offen lds
    s_add_u32 s61, s61, s68
    s_cmp_eq_u32 s61, s69
    s_cselect_b32 s61, 0, s61
    s_mov_b32 s67, 0
L_LD_Q:
    s_waitcnt vmcnt(13)
    s_barrier
    s_lshl_b32 s62, s60, 7
    s_add_u32 s63, s62, s86
    s_add_u32 s62, s62, s55
    s_mul_i32 s64, s60, 172032
    s_add_u32 s64, s64, s87
    s_add_u32 s60, s60, 1
    s_cmp_eq_u32 s60, 7
    s_cselect_b32 s60, 0, s60
    s_add_u32 s65, s58, s61
    s_add_u32 s56, s59, s61
    s_add_u32 m0, s65, 0
    s_nop 0
    buffer_load_dwordx4 v16, s[8:11], s62 offen lds
    s_add_u32 m0, s65, 1024
    s_nop 0
    buffer_load_dwordx4 v17, s[8:11], s62 offen lds
    s_add_u32 m0, s65, 2048
    s_nop 0
    buffer_load_dwordx4 v18, s[8:11], s62 offen lds
    s_add_u32 m0, s65, 3072
    s_nop 0
    buffer_load_dwordx4 v19, s[8:11], s62 offen lds
    s_add_u32 m0, s71, s61
    s_mov_b32 exec_hi, 0
    buffer_load_dwordx4 v22, s[8:11], s63 offen lds
    s_mov_b32 exec_hi, -1
    s_add_u32 m0, s56, 0
    s_nop 0
    buffer_load_dwordx4 v20, s[92:95], s64 offen lds
    s_add_u32 m0, s56, 1024
    s_nop 0
    buffer_load_dwordx4 v21, s[92:95], s64 offen lds
    s_add_u32 m0, s56, 8192
    s_nop 0
    buffer_load_dwordx4 v20, s[12:15], s64 offen lds
    s_add_u32 m0, s56, 9216
    s_nop 0
    buffer_load_dwordx4 v21, s[12:15], s64 offen lds
    s_add_u32 s66, s64, 896
    s_add_u32 m0, s56, 16384
    s_nop 0
    buffer_load_dwordx4 v20, s[12:15], s66 offen lds
    s_add_u32 m0, s56, 17408
    s_nop 0
    buffer_load_dwordx4 v21, s[12:15], s66 offen lds
    s_add_u32 s66, s64, 1792
    s_add_u32 m0, s56, 24576
    s_nop 0
    buffer_load_dwordx4 v20, s[12:15], s66 offen lds
    s_add_u32 m0, s56, 25600
    s_nop 0
    buffer_load_dwordx4 v21, s[12:15], s66 offen lds
    s_add_u32 s61, s61, s68
    s_cmp_eq_u32 s61, s69
    s_cselect_b32 s61, 0, s61
    s_add_u32 s67, s67, 1
    s_cmp_lt_u32 s67, 5
    s_cbranch_scc1 L_LD_Q
    s_waitcnt vmcnt(13)
    s_barrier
    s_lshl_b32 s53, s33, 1
    s_add_u32 s53, s53, s50
    s_mul_i32 s53, s53, 1568
    v_mul_u32_u24 v5, 224, v2
    v_lshl_add_u32 v3, v1, 1, v5
    v_add_u32 v6, 16, v1
    v_min_u32 v6, 27, v6
    v_lshl_add_u32 v6, v6, 1, v5
    buffer_load_ushort v100, v3, s[20:23], s53 offen offset:0
    buffer_load_ushort v101, v3, s[20:23], s53 offen offset:56
    buffer_load_ushort v102, v3, s[20:23], s53 offen offset:112
    buffer_load_ushort v103, v3, s[20:23], s53 offen offset:168
    buffer_load_ushort v104, v3, s[20:23], s53 offen offset:896
    buffer_load_ushort v105, v3, s[20:23], s53 offen offset:952
    buffer_load_ushort v106, v3, s[20:23], s53 offen offset:1008
    buffer_load_ushort v107, v3, s[20:23], s53 offen offset:1064
    buffer_load_ushort v108, v6, s[20:23], s53 offen offset:0
    buffer_load_ushort v109, v6, s[20:23], s53 offen offset:56
    buffer_load_ushort v110, v6, s[20:23], s53 offen offset:112
    buffer_load_ushort v111, v6, s[20:23], s53 offen offset:168
    buffer_load_ushort v112, v6, s[20:23], s53 offen offset:896
    buffer_load_ushort v113, v6, s[20:23], s53 offen offset:952
    buffer_load_ushort v114, v6, s[20:23], s53 offen offset:1008
    buffer_load_ushort v115, v6, s[20:23], s53 offen offset:1064
    v_cmp_le_u32 s[84:85], 48, v0
    v_mov_b32 v10, 0xff800000
    v_mov_b32 v12, 0x3f803f80
    v_mov_b32 v13, 0x3f803f80
    v_mov_b32 v14, 0x3f803f80
    v_mov_b32 v15, 0x3f803f80
    s_and_b32 s53, s35, 3
    s_mul_i32 s53, s53, 12288
    s_add_u32 s53, s53, 114688
    v_add_u32 v251, s53, v11
    s_mov_b32 s90, 0x3fb8aa3b
    v_lshrrev_b32 v247, 3, v0
    v_and_b32 v255, 6, v247
    v_mul_u32_u24 v247, 896, v247
    v_xor_b32 v255, v0, v255
    v_and_b32 v255, 7, v255
    v_lshl_add_u32 v247, v255, 4, v247
    s_mul_i32 s53, s35, 50176
    s_lshl_b32 s54, s47, 7
    s_add_u32 s53, s53, s54
    v_add_u32 v247, s53, v247
    s_mul_i32 s44, s35, 7168
    s_lshl_b32 s53, s32, 1
    s_add_u32 s53, s53, s51
    s_lshl_b32 s53, s53, 1
    s_add_u32 s53, s53, s52
    s_lshl_b32 s54, s33, 1
    s_add_u32 s54, s54, s50
    s_lshl_b32 s96, s53, 5
    s_add_u32 s96, s96, s54
    s_lshl_b32 s96, s96, 10
    s_lshl_b32 s97, s53, 8
    s_lshl_b32 s54, s54, 2
    s_add_u32 s97, s97, s54
    s_add_u32 s97, s97, 6307840
    s_lshr_b32 s40, s96, 14
    s_lshl_b32 s40, s40, 8
    s_add_u32 s40, s40, 4194304
    s_lshl_b32 s41, s33, 1
    s_add_u32 s41, s41, s50
    s_lshl_b32 s41, s41, 12
    s_add_u32 s41, s41, 4718592
    s_lshl_b32 s53, s32, 8
    s_lshl_b32 s54, s33, 8
    s_add_u32 s54, s54, 4096
    v_mov_b32 v249, s53
    v_mov_b32 v248, s54
    v_cmp_lt_u32 vcc, 15, v0
    s_nop 1
    v_cndmask_b32 v249, v249, v248, vcc
    v_lshl_add_u32 v249, v1, 2, v249
    s_mov_b32 s38, 6340608
    s_lshl_b32 s39, 1, s51
    s_lshl_b32 s53, s50, 1
    s_add_u32 s53, s53, 16
    s_lshl_b32 s53, 3, s53
    s_or_b32 s39, s39, s53
    s_mov_b32 s91, 0x358637bd
    v_mov_b32 v252, 0
    buffer_load_dword v254, v252, s[28:31], 0 offen sc1
    v_mov_b32 v240, -1
    v_mov_b32 v241, -1
    v_mov_b32 v242, -1
    v_mov_b32 v243, -1
    s_add_u32 s53, s96, 4294934528
    buffer_store_dwordx4 v[240:243], v11, s[16:19], s53 offen sc1
    s_add_u32 s53, s53, 16384
    buffer_store_dwordx4 v[240:243], v11, s[16:19], s53 offen sc1
    s_add_u32 s53, s53, 16384
    buffer_store_dwordx4 v[240:243], v11, s[16:19], s53 offen sc1
    s_add_u32 s53, s53, 16384
    buffer_store_dwordx4 v[240:243], v11, s[16:19], s53 offen sc1
    s_add_u32 s53, s53, 16384
    s_add_u32 s53, s96, 2064384
    buffer_store_dwordx4 v[240:243], v11, s[16:19], s53 offen sc1
    s_add_u32 s53, s53, 16384
    buffer_store_dwordx4 v[240:243], v11, s[16:19], s53 offen sc1
    s_add_u32 s53, s53, 16384
    buffer_store_dwordx4 v[240:243], v11, s[16:19], s53 offen sc1
    s_add_u32 s53, s53, 16384
    buffer_store_dwordx4 v[240:243], v11, s[16:19], s53 offen sc1
    s_add_u32 s53, s53, 16384
    s_waitcnt vmcnt(25)
    s_barrier
    s_waitcnt vmcnt(0)
    v_lshl_or_b32 v232, v101, 16, v100
    v_lshl_or_b32 v233, v103, 16, v102
    v_lshl_or_b32 v234, v105, 16, v104
    v_lshl_or_b32 v235, v107, 16, v106
    v_cndmask_b32_e64 v234, v234, 0, s[84:85]
    v_cndmask_b32_e64 v235, v235, 0, s[84:85]
    v_lshl_or_b32 v236, v109, 16, v108
    v_lshl_or_b32 v237, v111, 16, v110
    v_lshl_or_b32 v238, v113, 16, v112
    v_lshl_or_b32 v239, v115, 16, v114
    v_cndmask_b32_e64 v238, v238, 0, s[84:85]
    v_cndmask_b32_e64 v239, v239, 0, s[84:85]
    s_mov_b32 s3, 0
    s_nop 0
L_GN_1:
    v_readfirstlane_b32 s49, v254
    s_nop 0
    s_cmp_lg_u32 s49, 0
    s_nop 2
    s_cbranch_scc1 L_GNX_1
    s_sleep 2
    v_mov_b32 v252, 0
    buffer_load_dword v254, v252, s[28:31], 0 offen sc1
    s_waitcnt vmcnt(0)
    s_add_u32 s3, s3, 1
    s_cmp_lt_u32 s3, 200000
    s_cbranch_scc1 L_GN_1
L_GNX_1:
    s_barrier
    buffer_load_dword v253, v249, s[16:19], s38 offen sc1
    s_barrier
    ds_read_b128 v[16:19], v251 offset:0
    ds_read_b128 v[20:23], v251 offset:1024
    ds_read_b128 v[24:27], v251 offset:2048
    ds_read_b128 v[28:31], v251 offset:3072
    ds_read_b128 v[32:35], v251 offset:4096
    ds_read_b128 v[36:39], v251 offset:5120
    ds_read_b128 v[40:43], v251 offset:6144
    ds_read_b128 v[44:47], v251 offset:7168
    ds_read_b128 v[48:51], v251 offset:8192
    ds_read_b128 v[52:55], v251 offset:9216
    s_branch L_AQ_EPI
L_AQ_COMP:
    s_and_b32 s53, s2, 127
    s_mul_i32 s53, s53, 3136
    s_lshl_b32 s54, s35, 10
    s_add_u32 s53, s53, s54
    buffer_load_dwordx4 v[240:243], v11, s[72:75], s53 offen
    s_lshl_b32 s53, s33, 1
    s_add_u32 s53, s53, s50
    s_mul_i32 s53, s53, 1568
    v_mul_u32_u24 v5, 224, v2
    v_lshl_add_u32 v3, v1, 1, v5
    v_add_u32 v6, 16, v1
    v_min_u32 v6, 27, v6
    v_lshl_add_u32 v6, v6, 1, v5
    buffer_load_ushort v24, v3, s[20:23], s53 offen offset:0
    buffer_load_ushort v25, v3, s[20:23], s53 offen offset:56
    buffer_load_ushort v26, v3, s[20:23], s53 offen offset:112
    buffer_load_ushort v27, v3, s[20:23], s53 offen offset:168
    buffer_load_ushort v28, v3, s[20:23], s53 offen offset:896
    buffer_load_ushort v29, v3, s[20:23], s53 offen offset:952
    buffer_load_ushort v30, v3, s[20:23], s53 offen offset:1008
    buffer_load_ushort v31, v3, s[20:23], s53 offen offset:1064
    buffer_load_ushort v32, v6, s[20:23], s53 offen offset:0
    buffer_load_ushort v33, v6, s[20:23], s53 offen offset:56
    buffer_load_ushort v34, v6, s[20:23], s53 offen offset:112
    buffer_load_ushort v35, v6, s[20:23], s53 offen offset:168
    buffer_load_ushort v36, v6, s[20:23], s53 offen offset:896
    buffer_load_ushort v37, v6, s[20:23], s53 offen offset:952
    buffer_load_ushort v38, v6, s[20:23], s53 offen offset:1008
    buffer_load_ushort v39, v6, s[20:23], s53 offen offset:1064
    v_cmp_le_u32 s[84:85], 48, v0
    v_mov_b32 v10, 0xff800000
    v_mov_b32 v12, 0x3f803f80
    v_mov_b32 v13, 0x3f803f80
    v_mov_b32 v14, 0x3f803f80
    v_mov_b32 v15, 0x3f803f80
    s_and_b32 s53, s35, 3
    s_mul_i32 s53, s53, 12288
    s_add_u32 s53, s53, 114688
    v_add_u32 v251, s53, v11
    s_mov_b32 s90, 0x3fb8aa3b
    v_lshrrev_b32 v247, 3, v0
    v_and_b32 v255, 6, v247
    v_mul_u32_u24 v247, 896, v247
    v_xor_b32 v255, v0, v255
    v_and_b32 v255, 7, v255
    v_lshl_add_u32 v247, v255, 4, v247
    s_mul_i32 s53, s35, 50176
    s_lshl_b32 s54, s47, 7
    s_add_u32 s53, s53, s54
    v_add_u32 v247, s53, v247
    s_mul_i32 s44, s35, 7168
    s_lshl_b32 s53, s32, 1
    s_add_u32 s53, s53, s51
    s_lshl_b32 s53, s53, 1
    s_add_u32 s53, s53, s52
    s_lshl_b32 s54, s33, 1
    s_add_u32 s54, s54, s50
    s_lshl_b32 s96, s53, 5
    s_add_u32 s96, s96, s54
    s_lshl_b32 s96, s96, 10
    s_lshl_b32 s97, s53, 8
    s_lshl_b32 s54, s54, 2
    s_add_u32 s97, s97, s54
    s_add_u32 s97, s97, 6307840
    s_lshr_b32 s40, s96, 14
    s_lshl_b32 s40, s40, 8
    s_add_u32 s40, s40, 4194304
    s_lshl_b32 s41, s33, 1
    s_add_u32 s41, s41, s50
    s_lshl_b32 s41, s41, 12
    s_add_u32 s41, s41, 4718592
    s_lshl_b32 s53, s32, 8
    s_lshl_b32 s54, s33, 8
    s_add_u32 s54, s54, 4096
    v_mov_b32 v249, s53
    v_mov_b32 v248, s54
    v_cmp_lt_u32 vcc, 15, v0
    s_nop 1
    v_cndmask_b32 v249, v249, v248, vcc
    v_lshl_add_u32 v249, v1, 2, v249
    s_mov_b32 s38, 6340608
    s_lshl_b32 s39, 1, s51
    s_lshl_b32 s53, s50, 1
    s_add_u32 s53, s53, 16
    s_lshl_b32 s53, 3, s53
    s_or_b32 s39, s39, s53
    s_mov_b32 s91, 0x358637bd
    v_lshrrev_b32 v3, 2, v1
    v_and_b32 v16, 3, v0
    v_lshl_add_u32 v17, v2, 3, v3
    v_lshlrev_b32 v17, 7, v17
    v_lshrrev_b32 v18, 1, v3
    v_lshlrev_b32 v18, 1, v18
    v_and_b32 v19, 1, v2
    v_lshl_add_u32 v18, v19, 2, v18
    s_mul_i32 s53, s50, 56
    v_lshlrev_b32 v19, 3, v16
    v_add_u32 v19, s53, v19
    v_lshrrev_b32 v20, 4, v19
    v_xor_b32 v20, v20, v18
    v_lshlrev_b32 v20, 4, v20
    v_and_b32 v21, 8, v19
    v_add3_u32 v8, v17, v20, v21
    v_add_u32 v8, 18432, v8
    v_add_u32 v19, 32, v19
    v_lshrrev_b32 v20, 4, v19
    v_xor_b32 v20, v20, v18
    v_lshlrev_b32 v20, 4, v20
    v_and_b32 v21, 8, v19
    v_add3_u32 v9, v17, v20, v21
    v_add_u32 v9, 18432, v9
    v_lshrrev_b32 v3, 1, v1
    v_xor_b32 v4, v2, v3
    v_lshlrev_b32 v4, 4, v4
    v_lshl_add_u32 v4, v1, 7, v4
    s_mul_i32 s53, s51, 9216
    v_add_u32 v4, s53, v4
    v_xor_b32 v5, 64, v4
    v_or_b32 v16, 8, v1
    v_lshrrev_b32 v6, 1, v16
    v_xor_b32 v6, v2, v6
    v_lshlrev_b32 v6, 4, v6
    v_and_b32 v16, 7, v16
    v_lshl_add_u32 v6, v16, 7, v6
    s_mul_i32 s53, s51, 9216
    v_add_u32 v6, s53, v6
    v_xor_b32 v7, 64, v6
    v_mov_b32 v88, 0
    v_mov_b32 v89, 0
    v_mov_b32 v90, 0
    v_mov_b32 v91, 0
    v_mov_b32 v92, 0
    v_mov_b32 v93, 0
    v_mov_b32 v94, 0
    v_mov_b32 v95, 0
    v_mov_b32 v96, 0
    v_mov_b32 v97, 0
    v_mov_b32 v98, 0
    v_mov_b32 v99, 0
    v_mov_b32 v100, 0
    v_mov_b32 v101, 0
    v_mov_b32 v102, 0
    v_mov_b32 v103, 0
    v_mov_b32 v104, 0
    v_mov_b32 v105, 0
    v_mov_b32 v106, 0
    v_mov_b32 v107, 0
    v_mov_b32 v108, 0
    v_mov_b32 v109, 0
    v_mov_b32 v110, 0
    v_mov_b32 v111, 0
    v_mov_b32 v112, 0
    v_mov_b32 v113, 0
    v_mov_b32 v114, 0
    v_mov_b32 v115, 0
    v_mov_b32 v116, 0
    v_mov_b32 v117, 0
    v_mov_b32 v118, 0
    v_mov_b32 v119, 0
    v_mov_b32 v120, 0
    v_mov_b32 v121, 0
    v_mov_b32 v122, 0
    v_mov_b32 v123, 0
    v_mov_b32 v124, 0
    v_mov_b32 v125, 0
    v_mov_b32 v126, 0
    v_mov_b32 v127, 0
    v_mov_b32 v128, 0
    v_mov_b32 v129, 0
    v_mov_b32 v130, 0
    v_mov_b32 v131, 0
    v_mov_b32 v132, 0
    v_mov_b32 v133, 0
    v_mov_b32 v134, 0
    v_mov_b32 v135, 0
    v_mov_b32 v136, 0
    v_mov_b32 v137, 0
    v_mov_b32 v138, 0
    v_mov_b32 v139, 0
    v_mov_b32 v140, 0
    v_mov_b32 v141, 0
    v_mov_b32 v142, 0
    v_mov_b32 v143, 0
    v_mov_b32 v144, 0
    v_mov_b32 v145, 0
    v_mov_b32 v146, 0
    v_mov_b32 v147, 0
    v_mov_b32 v148, 0
    v_mov_b32 v149, 0
    v_mov_b32 v150, 0
    v_mov_b32 v151, 0
    v_mov_b32 v152, 0
    v_mov_b32 v153, 0
    v_mov_b32 v154, 0
    v_mov_b32 v155, 0
    v_mov_b32 v156, 0
    v_mov_b32 v157, 0
    v_mov_b32 v158, 0
    v_mov_b32 v159, 0
    v_mov_b32 v160, 0
    v_mov_b32 v161, 0
    v_mov_b32 v162, 0
    v_mov_b32 v163, 0
    v_mov_b32 v164, 0
    v_mov_b32 v165, 0
    v_mov_b32 v166, 0
    v_mov_b32 v167, 0
    v_mov_b32 v168, 0
    v_mov_b32 v169, 0
    v_mov_b32 v170, 0
    v_mov_b32 v171, 0
    v_mov_b32 v172, 0
    v_mov_b32 v173, 0
    v_mov_b32 v174, 0
    v_mov_b32 v175, 0
    v_mov_b32 v176, 0
    v_mov_b32 v177, 0
    v_mov_b32 v178, 0
    v_mov_b32 v179, 0
    v_mov_b32 v180, 0
    v_mov_b32 v181, 0
    v_mov_b32 v182, 0
    v_mov_b32 v183, 0
    v_mov_b32 v184, 0
    v_mov_b32 v185, 0
    v_mov_b32 v186, 0
    v_mov_b32 v187, 0
    v_mov_b32 v188, 0
    v_mov_b32 v189, 0
    v_mov_b32 v190, 0
    v_mov_b32 v191, 0
    v_mov_b32 v192, 0
    v_mov_b32 v193, 0
    v_mov_b32 v194, 0
    v_mov_b32 v195, 0
    v_mov_b32 v196, 0
    v_mov_b32 v197, 0
    v_mov_b32 v198, 0
    v_mov_b32 v199, 0
    v_mov_b32 v200, 0
    v_mov_b32 v201, 0
    v_mov_b32 v202, 0
    v_mov_b32 v203, 0
    v_mov_b32 v204, 0
    v_mov_b32 v205, 0
    v_mov_b32 v206, 0
    v_mov_b32 v207, 0
    v_mov_b32 v208, 0
    v_mov_b32 v209, 0
    v_mov_b32 v210, 0
    v_mov_b32 v211, 0
    v_mov_b32 v212, 0
    v_mov_b32 v213, 0
    v_mov_b32 v214, 0
    v_mov_b32 v215, 0
    v_mov_b32 v216, 0
    v_mov_b32 v217, 0
    v_mov_b32 v218, 0
    v_mov_b32 v219, 0
    v_mov_b32 v220, 0
    v_mov_b32 v221, 0
    v_mov_b32 v222, 0
    v_mov_b32 v223, 0
    v_mov_b32 v224, 0
    v_mov_b32 v225, 0
    v_mov_b32 v226, 0
    v_mov_b32 v227, 0
    v_mov_b32 v228, 0
    v_mov_b32 v229, 0
    v_mov_b32 v230, 0
    v_mov_b32 v231, 0
    s_waitcnt vmcnt(0)
    v_lshl_or_b32 v232, v25, 16, v24
    v_lshl_or_b32 v233, v27, 16, v26
    v_lshl_or_b32 v234, v29, 16, v28
    v_lshl_or_b32 v235, v31, 16, v30
    v_cndmask_b32_e64 v234, v234, 0, s[84:85]
    v_cndmask_b32_e64 v235, v235, 0, s[84:85]
    v_lshl_or_b32 v236, v33, 16, v32
    v_lshl_or_b32 v237, v35, 16, v34
    v_lshl_or_b32 v238, v37, 16, v36
    v_lshl_or_b32 v239, v39, 16, v38
    v_cndmask_b32_e64 v238, v238, 0, s[84:85]
    v_cndmask_b32_e64 v239, v239, 0, s[84:85]
    s_mov_b32 s68, 51200
    s_mov_b32 s69, 4294864896
    s_mov_b32 s67, 0
    s_mov_b32 s70, 0
    s_barrier
    ds_read_b128 v[16:19], v4 offset:1024
    ds_read_b128 v[20:23], v4 offset:3072
    ds_read_b128 v[24:27], v4 offset:5120
    ds_read_b128 v[28:31], v4 offset:7168
    ds_read_b128 v[32:35], v6
    ds_read_b64_tr_b16 v[56:57], v8 offset:0
    ds_read_b64_tr_b16 v[58:59], v8 offset:512
    ds_read_b64_tr_b16 v[60:61], v9 offset:0
    ds_read_b64_tr_b16 v[62:63], v9 offset:512
    ds_read_b64_tr_b16 v[64:65], v8 offset:8192
    ds_read_b64_tr_b16 v[66:67], v8 offset:8704
    ds_read_b64_tr_b16 v[68:69], v9 offset:8192
    ds_read_b64_tr_b16 v[70:71], v9 offset:8704
    ds_read_b64_tr_b16 v[72:73], v8 offset:16384
    ds_read_b64_tr_b16 v[74:75], v8 offset:16896
    ds_read_b64_tr_b16 v[76:77], v9 offset:16384
    ds_read_b64_tr_b16 v[78:79], v9 offset:16896
L_CP_Q:
    s_waitcnt lgkmcnt(8)
    v_mfma_f32_16x16x32_bf16 v[200:203], v[56:59], v[16:19], v[200:203]
    ds_read_b64_tr_b16 v[80:81], v8 offset:24576
    v_mfma_f32_16x16x32_bf16 v[204:207], v[60:63], v[16:19], v[204:207]
    ds_read_b64_tr_b16 v[82:83], v8 offset:25088
    v_mfma_f32_16x16x32_bf16 v[208:211], v[56:59], v[20:23], v[208:211]
    ds_read_b64_tr_b16 v[84:85], v9 offset:24576
    v_mfma_f32_16x16x32_bf16 v[212:215], v[60:63], v[20:23], v[212:215]
    ds_read_b64_tr_b16 v[86:87], v9 offset:25088
    v_mfma_f32_16x16x32_bf16 v[216:219], v[56:59], v[24:27], v[216:219]
    ds_read_b128 v[36:39], v5 offset:1024
    v_mfma_f32_16x16x32_bf16 v[220:223], v[60:63], v[24:27], v[220:223]
    ds_read_b128 v[40:43], v5 offset:3072
    v_mfma_f32_16x16x32_bf16 v[224:227], v[56:59], v[28:31], v[224:227]
    ds_read_b128 v[44:47], v5 offset:5120
    v_mfma_f32_16x16x32_bf16 v[228:231], v[60:63], v[28:31], v[228:231]
    ds_read_b128 v[48:51], v5 offset:7168
    ds_read_b128 v[52:55], v7
    s_waitcnt lgkmcnt(13)
    v_mfma_f32_16x16x32_bf16 v[88:91], v[64:67], v[16:19], v[88:91]
    ds_read_b64_tr_b16 v[56:57], v8 offset:4096
    v_mfma_f32_16x16x32_bf16 v[92:95], v[68:71], v[16:19], v[92:95]
    ds_read_b64_tr_b16 v[58:59], v8 offset:4608
    v_mfma_f32_16x16x32_bf16 v[96:99], v[64:67], v[20:23], v[96:99]
    ds_read_b64_tr_b16 v[60:61], v9 offset:4096
    v_mfma_f32_16x16x32_bf16 v[100:103], v[68:71], v[20:23], v[100:103]
    ds_read_b64_tr_b16 v[62:63], v9 offset:4608
    v_mfma_f32_16x16x32_bf16 v[104:107], v[64:67], v[24:27], v[104:107]
    v_mfma_f32_16x16x32_bf16 v[108:111], v[68:71], v[24:27], v[108:111]
    v_mfma_f32_16x16x32_bf16 v[112:115], v[64:67], v[28:31], v[112:115]
    v_mfma_f32_16x16x32_bf16 v[116:119], v[68:71], v[28:31], v[116:119]
    s_waitcnt lgkmcnt(13)
    v_mfma_f32_16x16x32_bf16 v[120:123], v[72:75], v[32:35], v[120:123]
    ds_read_b64_tr_b16 v[64:65], v8 offset:12288
    v_mfma_f32_16x16x32_bf16 v[124:127], v[76:79], v[32:35], v[124:127]
    ds_read_b64_tr_b16 v[66:67], v8 offset:12800
    v_mfma_f32_16x16x32_bf16 v[128:131], v[72:75], v[16:19], v[128:131]
    ds_read_b64_tr_b16 v[68:69], v9 offset:12288
    v_mfma_f32_16x16x32_bf16 v[132:135], v[76:79], v[16:19], v[132:135]
    ds_read_b64_tr_b16 v[70:71], v9 offset:12800
    v_mfma_f32_16x16x32_bf16 v[136:139], v[72:75], v[20:23], v[136:139]
    v_mfma_f32_16x16x32_bf16 v[140:143], v[76:79], v[20:23], v[140:143]
    v_mfma_f32_16x16x32_bf16 v[144:147], v[72:75], v[24:27], v[144:147]
    v_mfma_f32_16x16x32_bf16 v[148:151], v[76:79], v[24:27], v[148:151]
    v_mfma_f32_16x16x32_bf16 v[152:155], v[72:75], v[28:31], v[152:155]
    v_mfma_f32_16x16x32_bf16 v[156:159], v[76:79], v[28:31], v[156:159]
    s_waitcnt lgkmcnt(13)
    v_mfma_f32_16x16x32_bf16 v[160:163], v[32:35], v[80:83], v[160:163]
    ds_read_b64_tr_b16 v[72:73], v8 offset:20480
    v_mfma_f32_16x16x32_bf16 v[164:167], v[32:35], v[84:87], v[164:167]
    ds_read_b64_tr_b16 v[74:75], v8 offset:20992
    v_mfma_f32_16x16x32_bf16 v[168:171], v[16:19], v[80:83], v[168:171]
    ds_read_b64_tr_b16 v[76:77], v9 offset:20480
    v_mfma_f32_16x16x32_bf16 v[172:175], v[16:19], v[84:87], v[172:175]
    ds_read_b64_tr_b16 v[78:79], v9 offset:20992
    v_mfma_f32_16x16x32_bf16 v[176:179], v[20:23], v[80:83], v[176:179]
    v_mfma_f32_16x16x32_bf16 v[180:183], v[20:23], v[84:87], v[180:183]
    v_mfma_f32_16x16x32_bf16 v[184:187], v[24:27], v[80:83], v[184:187]
    v_mfma_f32_16x16x32_bf16 v[188:191], v[24:27], v[84:87], v[188:191]
    v_mfma_f32_16x16x32_bf16 v[192:195], v[28:31], v[80:83], v[192:195]
    v_mfma_f32_16x16x32_bf16 v[196:199], v[28:31], v[84:87], v[196:199]
    ds_read_b64_tr_b16 v[80:81], v8 offset:28672
    ds_read_b64_tr_b16 v[82:83], v8 offset:29184
    ds_read_b64_tr_b16 v[84:85], v9 offset:28672
    ds_read_b64_tr_b16 v[86:87], v9 offset:29184
    s_add_u32 s70, s70, 1
    s_cmp_eq_u32 s70, 3
    s_cselect_b32 s53, s69, s68
    s_cselect_b32 s70, 0, s70
    s_waitcnt lgkmcnt(0)
    v_add_u32 v4, s53, v4
    v_add_u32 v5, s53, v5
    v_add_u32 v6, s53, v6
    v_add_u32 v7, s53, v7
    v_add_u32 v8, s53, v8
    v_add_u32 v9, s53, v9
    s_barrier
    v_mfma_f32_16x16x32_bf16 v[200:203], v[56:59], v[36:39], v[200:203]
    ds_read_b128 v[16:19], v4 offset:1024
    v_mfma_f32_16x16x32_bf16 v[204:207], v[60:63], v[36:39], v[204:207]
    ds_read_b128 v[20:23], v4 offset:3072
    v_mfma_f32_16x16x32_bf16 v[208:211], v[56:59], v[40:43], v[208:211]
    ds_read_b128 v[24:27], v4 offset:5120
    v_mfma_f32_16x16x32_bf16 v[212:215], v[60:63], v[40:43], v[212:215]
    ds_read_b128 v[28:31], v4 offset:7168
    v_mfma_f32_16x16x32_bf16 v[216:219], v[56:59], v[44:47], v[216:219]
    ds_read_b128 v[32:35], v6
    v_mfma_f32_16x16x32_bf16 v[220:223], v[60:63], v[44:47], v[220:223]
    v_mfma_f32_16x16x32_bf16 v[224:227], v[56:59], v[48:51], v[224:227]
    v_mfma_f32_16x16x32_bf16 v[228:231], v[60:63], v[48:51], v[228:231]
    v_mfma_f32_16x16x32_bf16 v[88:91], v[64:67], v[36:39], v[88:91]
    ds_read_b64_tr_b16 v[56:57], v8 offset:0
    v_mfma_f32_16x16x32_bf16 v[92:95], v[68:71], v[36:39], v[92:95]
    ds_read_b64_tr_b16 v[58:59], v8 offset:512
    v_mfma_f32_16x16x32_bf16 v[96:99], v[64:67], v[40:43], v[96:99]
    ds_read_b64_tr_b16 v[60:61], v9 offset:0
    v_mfma_f32_16x16x32_bf16 v[100:103], v[68:71], v[40:43], v[100:103]
    ds_read_b64_tr_b16 v[62:63], v9 offset:512
    v_mfma_f32_16x16x32_bf16 v[104:107], v[64:67], v[44:47], v[104:107]
    v_mfma_f32_16x16x32_bf16 v[108:111], v[68:71], v[44:47], v[108:111]
    v_mfma_f32_16x16x32_bf16 v[112:115], v[64:67], v[48:51], v[112:115]
    v_mfma_f32_16x16x32_bf16 v[116:119], v[68:71], v[48:51], v[116:119]
    v_mfma_f32_16x16x32_bf16 v[120:123], v[72:75], v[52:55], v[120:123]
    ds_read_b64_tr_b16 v[64:65], v8 offset:8192
    v_mfma_f32_16x16x32_bf16 v[124:127], v[76:79], v[52:55], v[124:127]
    ds_read_b64_tr_b16 v[66:67], v8 offset:8704
    v_mfma_f32_16x16x32_bf16 v[128:131], v[72:75], v[36:39], v[128:131]
    ds_read_b64_tr_b16 v[68:69], v9 offset:8192
    v_mfma_f32_16x16x32_bf16 v[132:135], v[76:79], v[36:39], v[132:135]
    ds_read_b64_tr_b16 v[70:71], v9 offset:8704
    v_mfma_f32_16x16x32_bf16 v[136:139], v[72:75], v[40:43], v[136:139]
    v_mfma_f32_16x16x32_bf16 v[140:143], v[76:79], v[40:43], v[140:143]
    v_mfma_f32_16x16x32_bf16 v[144:147], v[72:75], v[44:47], v[144:147]
    v_mfma_f32_16x16x32_bf16 v[148:151], v[76:79], v[44:47], v[148:151]
    v_mfma_f32_16x16x32_bf16 v[152:155], v[72:75], v[48:51], v[152:155]
    v_mfma_f32_16x16x32_bf16 v[156:159], v[76:79], v[48:51], v[156:159]
    v_mfma_f32_16x16x32_bf16 v[160:163], v[52:55], v[80:83], v[160:163]
    ds_read_b64_tr_b16 v[72:73], v8 offset:16384
    v_mfma_f32_16x16x32_bf16 v[164:167], v[52:55], v[84:87], v[164:167]
    ds_read_b64_tr_b16 v[74:75], v8 offset:16896
    v_mfma_f32_16x16x32_bf16 v[168:171], v[36:39], v[80:83], v[168:171]
    ds_read_b64_tr_b16 v[76:77], v9 offset:16384
    v_mfma_f32_16x16x32_bf16 v[172:175], v[36:39], v[84:87], v[172:175]
    ds_read_b64_tr_b16 v[78:79], v9 offset:16896
    v_mfma_f32_16x16x32_bf16 v[176:179], v[40:43], v[80:83], v[176:179]
    v_mfma_f32_16x16x32_bf16 v[180:183], v[40:43], v[84:87], v[180:183]
    v_mfma_f32_16x16x32_bf16 v[184:187], v[44:47], v[80:83], v[184:187]
    v_mfma_f32_16x16x32_bf16 v[188:191], v[44:47], v[84:87], v[188:191]
    v_mfma_f32_16x16x32_bf16 v[192:195], v[48:51], v[80:83], v[192:195]
    v_mfma_f32_16x16x32_bf16 v[196:199], v[48:51], v[84:87], v[196:199]
    s_add_u32 s67, s67, 1
    s_cmp_lt_u32 s67, 7
    s_nop 5
    s_cbranch_scc1 L_CP_Q
    s_waitcnt lgkmcnt(0)
    s_waitcnt vmcnt(0)
    v_mov_b32 v252, 0
    buffer_load_dword v254, v252, s[28:31], 0 offen sc1
    v_cvt_pk_bf16_f32 v16, v104, v105
    v_cvt_pk_bf16_f32 v17, v106, v107
    v_cvt_pk_bf16_f32 v18, v108, v109
    v_cvt_pk_bf16_f32 v19, v110, v111
    v_cndmask_b32_e64 v18, v18, 0, s[84:85]
    v_cndmask_b32_e64 v19, v19, 0, s[84:85]
    v_cvt_pk_bf16_f32 v20, v112, v113
    v_cvt_pk_bf16_f32 v21, v114, v115
    v_cvt_pk_bf16_f32 v22, v116, v117
    v_cvt_pk_bf16_f32 v23, v118, v119
    v_cndmask_b32_e64 v22, v22, 0, s[84:85]
    v_cndmask_b32_e64 v23, v23, 0, s[84:85]
    v_cvt_pk_bf16_f32 v24, v136, v137
    v_cvt_pk_bf16_f32 v25, v138, v139
    v_cvt_pk_bf16_f32 v26, v140, v141
    v_cvt_pk_bf16_f32 v27, v142, v143
    v_cvt_pk_bf16_f32 v28, v144, v145
    v_cvt_pk_bf16_f32 v29, v146, v147
    v_cvt_pk_bf16_f32 v30, v148, v149
    v_cvt_pk_bf16_f32 v31, v150, v151
    v_cvt_pk_bf16_f32 v32, v152, v153
    v_cvt_pk_bf16_f32 v33, v154, v155
    v_cvt_pk_bf16_f32 v34, v156, v157
    v_cvt_pk_bf16_f32 v35, v158, v159
    v_cvt_pk_bf16_f32 v36, v176, v177
    v_cvt_pk_bf16_f32 v37, v178, v179
    v_cvt_pk_bf16_f32 v42, v180, v181
    v_cvt_pk_bf16_f32 v43, v182, v183
    v_cvt_pk_bf16_f32 v38, v184, v185
    v_cvt_pk_bf16_f32 v39, v186, v187
    v_cvt_pk_bf16_f32 v44, v188, v189
    v_cvt_pk_bf16_f32 v45, v190, v191
    v_cvt_pk_bf16_f32 v40, v192, v193
    v_cvt_pk_bf16_f32 v41, v194, v195
    v_cvt_pk_bf16_f32 v46, v196, v197
    v_cvt_pk_bf16_f32 v47, v198, v199
    v_cvt_pk_bf16_f32 v48, v216, v217
    v_cvt_pk_bf16_f32 v49, v218, v219
    v_cvt_pk_bf16_f32 v50, v220, v221
    v_cvt_pk_bf16_f32 v51, v222, v223
    v_cvt_pk_bf16_f32 v52, v224, v225
    v_cvt_pk_bf16_f32 v53, v226, v227
    v_cvt_pk_bf16_f32 v54, v228, v229
    v_cvt_pk_bf16_f32 v55, v230, v231
    ds_write_b128 v251, v[16:19] offset:0
    ds_write_b128 v251, v[20:23] offset:1024
    ds_write_b128 v251, v[24:27] offset:2048
    ds_write_b128 v251, v[28:31] offset:3072
    ds_write_b128 v251, v[32:35] offset:4096
    ds_write_b128 v251, v[36:39] offset:5120
    ds_write_b128 v251, v[40:43] offset:6144
    ds_write_b128 v251, v[44:47] offset:7168
    ds_write_b128 v251, v[48:51] offset:8192
    ds_write_b128 v251, v[52:55] offset:9216
    s_waitcnt lgkmcnt(0)
    s_barrier
    v_cvt_pk_bf16_f32 v16, v88, v89
    v_cvt_pk_bf16_f32 v17, v90, v91
    v_cvt_pk_bf16_f32 v18, v92, v93
    v_cvt_pk_bf16_f32 v19, v94, v95
    v_cndmask_b32_e64 v18, v18, 0, s[84:85]
    v_cndmask_b32_e64 v19, v19, 0, s[84:85]
    v_cvt_pk_bf16_f32 v20, v96, v97
    v_cvt_pk_bf16_f32 v21, v98, v99
    v_cvt_pk_bf16_f32 v22, v100, v101
    v_cvt_pk_bf16_f32 v23, v102, v103
    v_cndmask_b32_e64 v22, v22, 0, s[84:85]
    v_cndmask_b32_e64 v23, v23, 0, s[84:85]
    v_cvt_pk_bf16_f32 v24, v120, v121
    v_cvt_pk_bf16_f32 v25, v122, v123
    v_cvt_pk_bf16_f32 v26, v124, v125
    v_cvt_pk_bf16_f32 v27, v126, v127
    v_cvt_pk_bf16_f32 v28, v128, v129
    v_cvt_pk_bf16_f32 v29, v130, v131
    v_cvt_pk_bf16_f32 v30, v132, v133
    v_cvt_pk_bf16_f32 v31, v134, v135
    v_cvt_pk_bf16_f32 v32, v136, v137
    v_cvt_pk_bf16_f32 v33, v138, v139
    v_cvt_pk_bf16_f32 v34, v140, v141
    v_cvt_pk_bf16_f32 v35, v142, v143
    v_cvt_pk_bf16_f32 v36, v160, v161
    v_cvt_pk_bf16_f32 v37, v162, v163
    v_cvt_pk_bf16_f32 v42, v164, v165
    v_cvt_pk_bf16_f32 v43, v166, v167
    v_cvt_pk_bf16_f32 v38, v168, v169
    v_cvt_pk_bf16_f32 v39, v170, v171
    v_cvt_pk_bf16_f32 v44, v172, v173
    v_cvt_pk_bf16_f32 v45, v174, v175
    v_cvt_pk_bf16_f32 v40, v176, v177
    v_cvt_pk_bf16_f32 v41, v178, v179
    v_cvt_pk_bf16_f32 v46, v180, v181
    v_cvt_pk_bf16_f32 v47, v182, v183
    v_cvt_pk_bf16_f32 v48, v200, v201
    v_cvt_pk_bf16_f32 v49, v202, v203
    v_cvt_pk_bf16_f32 v50, v204, v205
    v_cvt_pk_bf16_f32 v51, v206, v207
    v_cvt_pk_bf16_f32 v52, v208, v209
    v_cvt_pk_bf16_f32 v53, v210, v211
    v_cvt_pk_bf16_f32 v54, v212, v213
    v_cvt_pk_bf16_f32 v55, v214, v215
    s_waitcnt vmcnt(0)
    s_mov_b32 s3, 0
L_GN_2:
    v_readfirstlane_b32 s49, v254
    s_nop 0
    s_cmp_lg_u32 s49, 0
    s_nop 2
    s_cbranch_scc1 L_GNX_2
    s_sleep 2
    v_mov_b32 v252, 0
    buffer_load_dword v254, v252, s[28:31], 0 offen sc1
    s_waitcnt vmcnt(0)
    s_add_u32 s3, s3, 1
    s_cmp_lt_u32 s3, 200000
    s_cbranch_scc1 L_GN_2
L_GNX_2:
    buffer_load_dword v253, v249, s[16:19], s38 offen sc1
L_AQ_EPI:
    v_mov_b32 v252, 0
    v_mov_b32 v255, s49
    s_mov_b64 exec, 1
    buffer_store_dword v255, v252, s[16:19], s97 offen sc1
    s_mov_b64 exec, -1
    v_lshlrev_b32 v3, 2, v2
    v_add_u32 v4, 9, v1
    v_add_u32 v5, 0, v3
    v_cmp_ge_u32 s[56:57], v5, v4
    v_sub_u32 v6, v1, v5
    v_cmp_gt_u32 s[64:65], 8, v6
    v_add_u32 v5, 1, v3
    v_cmp_ge_u32 s[58:59], v5, v4
    v_sub_u32 v6, v1, v5
    v_cmp_gt_u32 s[66:67], 8, v6
    v_add_u32 v5, 2, v3
    v_cmp_ge_u32 s[60:61], v5, v4
    v_sub_u32 v6, v1, v5
    v_cmp_gt_u32 s[68:69], 8, v6
    v_add_u32 v5, 3, v3
    v_cmp_ge_u32 s[62:63], v5, v4
    v_sub_u32 v6, v1, v5
    v_cmp_gt_u32 s[70:71], 8, v6
    s_or_b32 s53, s32, s52
    s_cmp_eq_u32 s53, 0
    s_cselect_b64 s[36:37], 0, s[56:57]
    s_cselect_b64 s[42:43], 0, s[58:59]
    s_cselect_b64 s[86:87], 0, s[60:61]
    s_cselect_b64 s[100:101], 0, s[62:63]
    s_waitcnt lgkmcnt(0)
    v_mfma_f32_16x16x32_bf16 v[88:91], v[24:27], v[16:19], 0
    v_mfma_f32_16x16x32_bf16 v[92:95], v[28:31], v[16:19], 0
    v_mfma_f32_16x16x32_bf16 v[96:99], v[28:31], v[20:23], 0
    v_mfma_f32_16x16x32_bf16 v[100:103], v[32:35], v[20:23], 0
    s_nop 4
    v_cndmask_b32_e64 v88, v10, v88, s[36:37]
    v_cndmask_b32_e64 v92, v10, v92, s[64:65]
    v_cndmask_b32_e64 v89, v10, v89, s[42:43]
    v_cndmask_b32_e64 v93, v10, v93, s[66:67]
    v_cndmask_b32_e64 v90, v10, v90, s[86:87]
    v_cndmask_b32_e64 v94, v10, v94, s[68:69]
    v_cndmask_b32_e64 v91, v10, v91, s[100:101]
    v_cndmask_b32_e64 v95, v10, v95, s[70:71]
    v_max3_f32 v104, v88, v89, v90
    v_max3_f32 v104, v104, v91, v92
    v_max3_f32 v104, v104, v93, v94
    v_max_f32 v104, v104, v95
    v_cndmask_b32_e64 v96, v10, v96, s[56:57]
    v_cndmask_b32_e64 v100, v10, v100, s[64:65]
    v_cndmask_b32_e64 v97, v10, v97, s[58:59]
    v_cndmask_b32_e64 v101, v10, v101, s[66:67]
    v_cndmask_b32_e64 v98, v10, v98, s[60:61]
    v_cndmask_b32_e64 v102, v10, v102, s[68:69]
    v_cndmask_b32_e64 v99, v10, v99, s[62:63]
    v_cndmask_b32_e64 v103, v10, v103, s[70:71]
    v_max3_f32 v105, v96, v97, v98
    v_max3_f32 v105, v105, v99, v100
    v_max3_f32 v105, v105, v101, v102
    v_max_f32 v105, v105, v103
    s_nop 1
    v_permlane32_swap_b32 v104, v105
    v_max_f32 v104, v104, v105
    v_mov_b32 v105, v104
    s_nop 1
    v_permlane16_swap_b32 v104, v105
    v_max_f32 v104, v104, v105
    v_mov_b32 v105, v104
    s_nop 1
    v_permlane32_swap_b32 v104, v105
    s_mov_b32 s3, 0
    s_nop 0
L_PA_3:
    s_waitcnt vmcnt(0)
    v_cmp_eq_u32 vcc, s49, v253
    s_nop 0
    s_and_b32 s4, vcc_lo, s39
    s_cmp_eq_u32 s4, s39
    s_nop 1
    s_cbranch_scc1 L_PAX_3
    s_sleep 1
    buffer_load_dword v253, v249, s[16:19], s38 offen sc1
    s_add_u32 s3, s3, 1
    s_cmp_lt_u32 s3, 200000
    s_cbranch_scc1 L_PA_3
L_PAX_3:
    v_lshlrev_b32 v3, 2, v0
    buffer_load_dword v56, v3, s[16:19], s40 offen offset:0 sc1
    buffer_load_dword v57, v3, s[16:19], s40 offen offset:256 sc1
    s_mov_b32 s88, 0x3e8b97f6
    v_mul_f32 v104, s88, v104
    v_fma_f32 v88, v88, s88, -v104
    v_fma_f32 v89, v89, s88, -v104
    v_fma_f32 v90, v90, s88, -v104
    v_fma_f32 v91, v91, s88, -v104
    s_add_u32 m0, s44, 57344
    s_mov_b32 s5, 0
    buffer_load_dwordx4 v247, s[72:75], s5 offen lds
    v_fma_f32 v92, v92, s88, -v104
    v_fma_f32 v93, v93, s88, -v104
    v_fma_f32 v94, v94, s88, -v104
    v_fma_f32 v95, v95, s88, -v104
    s_add_u32 m0, s44, 58368
    s_mov_b32 s5, 7168
    buffer_load_dwordx4 v247, s[72:75], s5 offen lds
    v_exp_f32 v88, v88
    v_exp_f32 v89, v89
    v_exp_f32 v90, v90
    v_exp_f32 v91, v91
    s_add_u32 m0, s44, 59392
    s_mov_b32 s5, 14336
    buffer_load_dwordx4 v247, s[72:75], s5 offen lds
    v_exp_f32 v92, v92
    v_exp_f32 v93, v93
    v_exp_f32 v94, v94
    v_exp_f32 v95, v95
    s_add_u32 m0, s44, 60416
    s_mov_b32 s5, 21504
    buffer_load_dwordx4 v247, s[72:75], s5 offen lds
    v_cvt_pk_bf16_f32 v108, v88, v89
    v_cvt_pk_bf16_f32 v109, v90, v91
    v_cvt_pk_bf16_f32 v110, v92, v93
    v_cvt_pk_bf16_f32 v111, v94, v95
    s_nop 1
    v_mfma_f32_16x16x32_bf16 v[124:127], v[12:15], v[108:111], 0
    v_mfma_f32_16x16x32_bf16 v[116:119], v[36:39], v[108:111], 0
    v_mfma_f32_16x16x32_bf16 v[120:123], v[42:45], v[108:111], 0
    v_mul_f32 v105, s88, v105
    v_fma_f32 v96, v96, s88, -v105
    v_fma_f32 v97, v97, s88, -v105
    v_fma_f32 v98, v98, s88, -v105
    v_fma_f32 v99, v99, s88, -v105
    s_add_u32 m0, s44, 61440
    s_mov_b32 s5, 28672
    buffer_load_dwordx4 v247, s[72:75], s5 offen lds
    v_fma_f32 v100, v100, s88, -v105
    v_fma_f32 v101, v101, s88, -v105
    v_fma_f32 v102, v102, s88, -v105
    v_fma_f32 v103, v103, s88, -v105
    s_add_u32 m0, s44, 62464
    s_mov_b32 s5, 35840
    buffer_load_dwordx4 v247, s[72:75], s5 offen lds
    v_exp_f32 v96, v96
    v_exp_f32 v97, v97
    v_exp_f32 v98, v98
    v_exp_f32 v99, v99
    s_add_u32 m0, s44, 63488
    s_mov_b32 s5, 43008
    buffer_load_dwordx4 v247, s[72:75], s5 offen lds
    v_exp_f32 v100, v100
    v_exp_f32 v101, v101
    v_exp_f32 v102, v102
    v_exp_f32 v103, v103
    v_cvt_pk_bf16_f32 v112, v96, v97
    v_cvt_pk_bf16_f32 v113, v98, v99
    v_cvt_pk_bf16_f32 v114, v100, v101
    v_cvt_pk_bf16_f32 v115, v102, v103
    s_nop 1
    v_mfma_f32_16x16x32_bf16 v[136:139], v[12:15], v[112:115], 0
    v_mfma_f32_16x16x32_bf16 v[128:131], v[38:41], v[112:115], 0
    v_mfma_f32_16x16x32_bf16 v[132:135], v[44:47], v[112:115], 0
    s_mov_b32 s53, s96
    s_waitcnt vmcnt(7)
    v_rcp_f32 v124, v124
    s_nop 0
    v_mul_f32 v124, v124, v56
    v_pk_mul_f32 v[116:117], v[116:117], v[124:125] op_sel_hi:[1,0]
    v_pk_mul_f32 v[118:119], v[118:119], v[124:125] op_sel_hi:[1,0]
    v_pk_mul_f32 v[120:121], v[120:121], v[124:125] op_sel_hi:[1,0]
    v_pk_mul_f32 v[122:123], v[122:123], v[124:125] op_sel_hi:[1,0]
    v_cvt_pk_bf16_f32 v140, v116, v117
    v_cvt_pk_bf16_f32 v141, v118, v119
    v_cvt_pk_bf16_f32 v142, v120, v121
    v_cvt_pk_bf16_f32 v143, v122, v123
    v_cndmask_b32_e64 v142, v142, 0, s[84:85]
    v_cndmask_b32_e64 v143, v143, 0, s[84:85]
    v_min_u32 v140, 0xfffffffe, v140
    v_min_u32 v141, 0xfffffffe, v141
    v_min_u32 v142, 0xfffffffe, v142
    v_min_u32 v143, 0xfffffffe, v143
    buffer_store_dwordx4 v[140:143], v11, s[16:19], s53 offen sc1
    s_add_u32 s53, s53, 16384
    v_rcp_f32 v136, v136
    s_nop 0
    v_mul_f32 v136, v136, v57
    v_pk_mul_f32 v[128:129], v[128:129], v[136:137] op_sel_hi:[1,0]
    v_pk_mul_f32 v[130:131], v[130:131], v[136:137] op_sel_hi:[1,0]
    v_pk_mul_f32 v[132:133], v[132:133], v[136:137] op_sel_hi:[1,0]
    v_pk_mul_f32 v[134:135], v[134:135], v[136:137] op_sel_hi:[1,0]
    v_cvt_pk_bf16_f32 v144, v128, v129
    v_cvt_pk_bf16_f32 v145, v130, v131
    v_cvt_pk_bf16_f32 v146, v132, v133
    v_cvt_pk_bf16_f32 v147, v134, v135
    v_cndmask_b32_e64 v146, v146, 0, s[84:85]
    v_cndmask_b32_e64 v147, v147, 0, s[84:85]
    v_min_u32 v144, 0xfffffffe, v144
    v_min_u32 v145, 0xfffffffe, v145
    v_min_u32 v146, 0xfffffffe, v146
    v_min_u32 v147, 0xfffffffe, v147
    buffer_store_dwordx4 v[144:147], v11, s[16:19], s53 offen sc1
    s_add_u32 s53, s53, 16384
    v_mfma_f32_16x16x32_bf16 v[16:19], v[232:235], v[48:51], 0
    v_mfma_f32_16x16x32_bf16 v[20:23], v[236:239], v[48:51], 0
    v_mfma_f32_16x16x32_bf16 v[24:27], v[232:235], v[52:55], 0
    v_mfma_f32_16x16x32_bf16 v[28:31], v[236:239], v[52:55], 0
    s_nop 4
    v_max3_f32 v32, v16, v17, v18
    v_max3_f32 v32, v32, v19, v20
    v_max3_f32 v32, v32, v21, v22
    v_max_f32_e64 v32, v32, v23
    v_max3_f32 v34, -v16, -v17, -v18
    v_max3_f32 v34, v34, -v19, -v20
    v_max3_f32 v34, v34, -v21, -v22
    v_max_f32_e64 v34, v34, -v23
    v_max3_f32 v33, v24, v25, v26
    v_max3_f32 v33, v33, v27, v28
    v_max3_f32 v33, v33, v29, v30
    v_max_f32_e64 v33, v33, v31
    v_max3_f32 v35, -v24, -v25, -v26
    v_max3_f32 v35, v35, -v27, -v28
    v_max3_f32 v35, v35, -v29, -v30
    v_max_f32_e64 v35, v35, -v31
    v_permlane32_swap_b32 v32, v33
    s_nop 0
    v_permlane32_swap_b32 v34, v35
    v_max_f32 v32, v32, v33
    v_max_f32 v34, v34, v35
    s_nop 1
    v_permlane16_swap_b32 v32, v34
    v_max_f32 v32, v32, v34
    v_mov_b32 v34, v32
    s_nop 1
    v_permlane16_swap_b32 v32, v34
    v_mov_b32 v33, v32
    v_mov_b32 v35, v34
    s_nop 0
    v_permlane32_swap_b32 v32, v33
    v_permlane32_swap_b32 v34, v35
    v_mul_f32_e64 v32, -s90, v32
    v_cndmask_b32_e64 v36, v32, v10, s[84:85]
    v_mul_f32_e64 v33, -s90, v33
    v_cndmask_b32_e64 v37, v33, v10, s[84:85]
    v_mul_f32_e64 v34, -s90, v34
    v_cndmask_b32_e64 v38, v34, v10, s[84:85]
    v_mul_f32_e64 v35, -s90, v35
    v_cndmask_b32_e64 v39, v35, v10, s[84:85]
    v_fma_f32 v200, v16, s90, v32
    v_fma_f32 v201, v17, s90, v32
    v_fma_f32 v202, v18, s90, v32
    v_fma_f32 v203, v19, s90, v32
    v_fma_f32 v204, v20, s90, v36
    v_fma_f32 v205, v21, s90, v36
    v_fma_f32 v206, v22, s90, v36
    s_add_u32 m0, s44, 0
    s_mov_b32 s5, 0
    buffer_load_dwordx4 v247, s[76:79], s5 offen lds
    v_fma_f32 v207, v23, s90, v36
    v_exp_f32 v200, v200
    v_exp_f32 v201, v201
    v_exp_f32 v202, v202
    v_exp_f32 v203, v203
    v_exp_f32 v204, v204
    v_exp_f32 v205, v205
    s_add_u32 m0, s44, 1024
    s_mov_b32 s5, 7168
    buffer_load_dwordx4 v247, s[76:79], s5 offen lds
    v_exp_f32 v206, v206
    v_exp_f32 v207, v207
    v_cvt_pk_bf16_f32 v76, v200, v201
    v_cvt_pk_bf16_f32 v77, v202, v203
    v_cvt_pk_bf16_f32 v78, v204, v205
    v_cvt_pk_bf16_f32 v79, v206, v207
    s_nop 1
    v_mfma_f32_16x16x32_bf16 v[60:63], v[12:15], v[76:79], 0
    v_fma_f32 v208, v24, s90, v33
    v_fma_f32 v209, v25, s90, v33
    v_fma_f32 v210, v26, s90, v33
    v_fma_f32 v211, v27, s90, v33
    v_fma_f32 v212, v28, s90, v37
    s_add_u32 m0, s44, 2048
    s_mov_b32 s5, 14336
    buffer_load_dwordx4 v247, s[76:79], s5 offen lds
    v_fma_f32 v213, v29, s90, v37
    v_fma_f32 v214, v30, s90, v37
    v_fma_f32 v215, v31, s90, v37
    v_exp_f32 v208, v208
    v_exp_f32 v209, v209
    v_exp_f32 v210, v210
    v_exp_f32 v211, v211
    s_add_u32 m0, s44, 3072
    s_mov_b32 s5, 21504
    buffer_load_dwordx4 v247, s[76:79], s5 offen lds
    v_exp_f32 v212, v212
    v_exp_f32 v213, v213
    v_exp_f32 v214, v214
    v_exp_f32 v215, v215
    v_cvt_pk_bf16_f32 v80, v208, v209
    v_cvt_pk_bf16_f32 v81, v210, v211
    v_cvt_pk_bf16_f32 v82, v212, v213
    v_cvt_pk_bf16_f32 v83, v214, v215
    s_nop 1
    v_mfma_f32_16x16x32_bf16 v[64:67], v[12:15], v[80:83], 0
    v_fma_f32 v216, -v16, s90, v34
    v_fma_f32 v217, -v17, s90, v34
    v_fma_f32 v218, -v18, s90, v34
    s_add_u32 m0, s44, 4096
    s_mov_b32 s5, 28672
    buffer_load_dwordx4 v247, s[76:79], s5 offen lds
    v_fma_f32 v219, -v19, s90, v34
    v_fma_f32 v220, -v20, s90, v38
    v_fma_f32 v221, -v21, s90, v38
    v_fma_f32 v222, -v22, s90, v38
    v_fma_f32 v223, -v23, s90, v38
    v_exp_f32 v216, v216
    v_exp_f32 v217, v217
    s_add_u32 m0, s44, 5120
    s_mov_b32 s5, 35840
    buffer_load_dwordx4 v247, s[76:79], s5 offen lds
    v_exp_f32 v218, v218
    v_exp_f32 v219, v219
    v_exp_f32 v220, v220
    v_exp_f32 v221, v221
    v_exp_f32 v222, v222
    v_exp_f32 v223, v223
    v_cvt_pk_bf16_f32 v84, v216, v217
    v_cvt_pk_bf16_f32 v85, v218, v219
    v_cvt_pk_bf16_f32 v86, v220, v221
    v_cvt_pk_bf16_f32 v87, v222, v223
    s_nop 1
    v_mfma_f32_16x16x32_bf16 v[68:71], v[12:15], v[84:87], 0
    v_fma_f32 v224, -v24, s90, v35
    s_add_u32 m0, s44, 6144
    s_mov_b32 s5, 43008
    buffer_load_dwordx4 v247, s[76:79], s5 offen lds
    v_fma_f32 v225, -v25, s90, v35
    v_fma_f32 v226, -v26, s90, v35
    v_fma_f32 v227, -v27, s90, v35
    v_fma_f32 v228, -v28, s90, v39
    v_fma_f32 v229, -v29, s90, v39
    v_fma_f32 v230, -v30, s90, v39
    v_fma_f32 v231, -v31, s90, v39
    v_exp_f32 v224, v224
    v_exp_f32 v225, v225
    v_exp_f32 v226, v226
    v_exp_f32 v227, v227
    v_exp_f32 v228, v228
    v_exp_f32 v229, v229
    v_exp_f32 v230, v230
    v_exp_f32 v231, v231
    v_cvt_pk_bf16_f32 v88, v224, v225
    v_cvt_pk_bf16_f32 v89, v226, v227
    v_cvt_pk_bf16_f32 v90, v228, v229
    v_cvt_pk_bf16_f32 v91, v230, v231
    s_nop 1
    v_mfma_f32_16x16x32_bf16 v[72:75], v[12:15], v[88:91], 0
    buffer_load_dwordx4 v[16:19], v11, s[16:19], s41 offen offset:0 sc1
    buffer_load_dwordx4 v[20:23], v11, s[16:19], s41 offen offset:1024 sc1
    buffer_load_dwordx4 v[24:27], v11, s[16:19], s41 offen offset:2048 sc1
    buffer_load_dwordx4 v[28:31], v11, s[16:19], s41 offen offset:3072 sc1
    s_add_u32 s53, s97, 16384
    v_mov_b32 v252, 0
    v_mov_b32 v255, s49
    s_mov_b64 exec, 1
    buffer_store_dword v255, v252, s[16:19], s53 offen sc1
    s_mov_b64 exec, -1
    v_rcp_f32 v60, v60
    v_rcp_f32 v64, v64
    v_rcp_f32 v68, v68
    v_rcp_f32 v72, v72
    v_pk_mul_f32 v[200:201], v[200:201], v[60:61] op_sel_hi:[1,0]
    v_pk_mul_f32 v[202:203], v[202:203], v[60:61] op_sel_hi:[1,0]
    v_pk_mul_f32 v[204:205], v[204:205], v[60:61] op_sel_hi:[1,0]
    v_pk_mul_f32 v[206:207], v[206:207], v[60:61] op_sel_hi:[1,0]
    v_cvt_pk_bf16_f32 v76, v200, v201
    v_cvt_pk_bf16_f32 v77, v202, v203
    v_cvt_pk_bf16_f32 v78, v204, v205
    v_cvt_pk_bf16_f32 v79, v206, v207
    v_pk_mul_f32 v[208:209], v[208:209], v[64:65] op_sel_hi:[1,0]
    v_pk_mul_f32 v[210:211], v[210:211], v[64:65] op_sel_hi:[1,0]
    v_pk_mul_f32 v[212:213], v[212:213], v[64:65] op_sel_hi:[1,0]
    v_pk_mul_f32 v[214:215], v[214:215], v[64:65] op_sel_hi:[1,0]
    v_cvt_pk_bf16_f32 v80, v208, v209
    v_cvt_pk_bf16_f32 v81, v210, v211
    v_cvt_pk_bf16_f32 v82, v212, v213
    v_cvt_pk_bf16_f32 v83, v214, v215
    v_pk_mul_f32 v[216:217], v[216:217], v[68:69] op_sel_hi:[1,0]
    v_pk_mul_f32 v[218:219], v[218:219], v[68:69] op_sel_hi:[1,0]
    v_pk_mul_f32 v[220:221], v[220:221], v[68:69] op_sel_hi:[1,0]
    v_pk_mul_f32 v[222:223], v[222:223], v[68:69] op_sel_hi:[1,0]
    v_cvt_pk_bf16_f32 v84, v216, v217
    v_cvt_pk_bf16_f32 v85, v218, v219
    v_cvt_pk_bf16_f32 v86, v220, v221
    v_cvt_pk_bf16_f32 v87, v222, v223
    v_pk_mul_f32 v[224:225], v[224:225], v[72:73] op_sel_hi:[1,0]
    v_pk_mul_f32 v[226:227], v[226:227], v[72:73] op_sel_hi:[1,0]
    v_pk_mul_f32 v[228:229], v[228:229], v[72:73] op_sel_hi:[1,0]
    v_pk_mul_f32 v[230:231], v[230:231], v[72:73] op_sel_hi:[1,0]
    v_cvt_pk_bf16_f32 v88, v224, v225
    v_cvt_pk_bf16_f32 v89, v226, v227
    v_cvt_pk_bf16_f32 v90, v228, v229
    v_cvt_pk_bf16_f32 v91, v230, v231
    s_mov_b32 s3, 0
    s_nop 0
L_KVW:
    s_waitcnt vmcnt(0)
    v_max3_u32 v255, v16, v17, v18
    v_max3_u32 v255, v255, v19, v20
    v_max3_u32 v255, v255, v21, v22
    v_max3_u32 v255, v255, v23, v24
    v_max3_u32 v255, v255, v25, v26
    v_max3_u32 v255, v255, v27, v28
    v_max3_u32 v255, v255, v29, v30
    v_max_u32 v255, v255, v31
    v_cmp_eq_u32 vcc, -1, v255
    s_nop 0
    s_cmp_lg_u64 vcc, 0
    s_nop 2
    s_cbranch_scc0 L_KVOK
    buffer_load_dwordx4 v[16:19], v11, s[16:19], s41 offen offset:0 sc1
    buffer_load_dwordx4 v[20:23], v11, s[16:19], s41 offen offset:1024 sc1
    buffer_load_dwordx4 v[24:27], v11, s[16:19], s41 offen offset:2048 sc1
    buffer_load_dwordx4 v[28:31], v11, s[16:19], s41 offen offset:3072 sc1
    s_add_u32 s3, s3, 1
    s_cmp_lt_u32 s3, 200000
    s_cbranch_scc1 L_KVW
    s_waitcnt vmcnt(0)
L_KVOK:
    v_mfma_f32_16x16x32_bf16 v[200:203], v[16:19], v[76:79], 0
    v_mfma_f32_16x16x32_bf16 v[204:207], v[20:23], v[76:79], 0
    v_mfma_f32_16x16x32_bf16 v[208:211], v[16:19], v[80:83], 0
    v_mfma_f32_16x16x32_bf16 v[212:215], v[20:23], v[80:83], 0
    v_mfma_f32_16x16x32_bf16 v[204:207], v[28:31], v[84:87], v[204:207]
    v_mfma_f32_16x16x32_bf16 v[200:203], v[24:27], v[84:87], v[200:203]
    v_mfma_f32_16x16x32_bf16 v[212:215], v[28:31], v[88:91], v[212:215]
    v_mfma_f32_16x16x32_bf16 v[208:211], v[24:27], v[88:91], v[208:211]
    v_sub_f32 v58, 1.0, v56
    v_sub_f32 v59, 1.0, v57
    s_add_u32 s53, s96, 2097152
    s_nop 1
    v_mov_b32 v216, v204
    s_nop 0
    v_mov_b32 v217, v212
    s_nop 1
    v_permlane32_swap_b32 v216, v217
    v_mov_b32 v216, v217
    s_nop 1
    v_permlane16_swap_b32 v217, v216
    v_add_f32 v216, s91, v216
    v_rcp_f32 v216, v216
    s_nop 0
    v_mov_b32 v217, v216
    s_nop 1
    v_permlane32_swap_b32 v216, v217
    v_mul_f32 v218, v216, v58
    v_pk_mul_f32 v[200:201], v[200:201], v[218:219] op_sel_hi:[1,0]
    v_pk_mul_f32 v[202:203], v[202:203], v[218:219] op_sel_hi:[1,0]
    v_pk_mul_f32 v[204:205], v[204:205], v[218:219] op_sel_hi:[1,0]
    v_pk_mul_f32 v[206:207], v[206:207], v[218:219] op_sel_hi:[1,0]
    v_cvt_pk_bf16_f32 v224, v200, v201
    v_cvt_pk_bf16_f32 v225, v202, v203
    v_cvt_pk_bf16_f32 v226, v204, v205
    v_cvt_pk_bf16_f32 v227, v206, v207
    v_cndmask_b32_e64 v226, v226, 0, s[84:85]
    v_cndmask_b32_e64 v227, v227, 0, s[84:85]
    v_min_u32 v224, 0xfffffffe, v224
    v_min_u32 v225, 0xfffffffe, v225
    v_min_u32 v226, 0xfffffffe, v226
    v_min_u32 v227, 0xfffffffe, v227
    buffer_store_dwordx4 v[224:227], v11, s[16:19], s53 offen sc1
    s_add_u32 s53, s53, 16384
    v_mul_f32 v220, v217, v59
    v_pk_mul_f32 v[208:209], v[208:209], v[220:221] op_sel_hi:[1,0]
    v_pk_mul_f32 v[210:211], v[210:211], v[220:221] op_sel_hi:[1,0]
    v_pk_mul_f32 v[212:213], v[212:213], v[220:221] op_sel_hi:[1,0]
    v_pk_mul_f32 v[214:215], v[214:215], v[220:221] op_sel_hi:[1,0]
    v_cvt_pk_bf16_f32 v228, v208, v209
    v_cvt_pk_bf16_f32 v229, v210, v211
    v_cvt_pk_bf16_f32 v230, v212, v213
    v_cvt_pk_bf16_f32 v231, v214, v215
    v_cndmask_b32_e64 v230, v230, 0, s[84:85]
    v_cndmask_b32_e64 v231, v231, 0, s[84:85]
    v_min_u32 v228, 0xfffffffe, v228
    v_min_u32 v229, 0xfffffffe, v229
    v_min_u32 v230, 0xfffffffe, v230
    v_min_u32 v231, 0xfffffffe, v231
    buffer_store_dwordx4 v[228:231], v11, s[16:19], s53 offen sc1
    s_add_u32 s53, s53, 16384
    s_cmp_ge_u32 s45, 14
    s_cbranch_scc1 L_END
    v_lshrrev_b32 v3, 2, v1
    v_and_b32 v4, 3, v0
    v_lshl_add_u32 v5, v2, 2, v3
    v_lshlrev_b32 v5, 7, v5
    v_lshl_add_u32 v5, v4, 3, v5
    s_mul_i32 s53, s52, 28672
    s_add_u32 s53, s53, 57344
    v_add_u32 v5, s53, v5
    v_lshrrev_b32 v6, 1, v3
    v_lshl_add_u32 v6, v2, 1, v6
    v_add_u32 v8, 0, v6
    v_and_b32 v8, 3, v8
    v_xor_b32 v9, 0, v8
    v_lshl_add_u32 v16, v9, 5, v5
    v_xor_b32 v9, 1, v8
    v_lshl_add_u32 v17, v9, 5, v5
    v_xor_b32 v9, 2, v8
    v_lshl_add_u32 v18, v9, 5, v5
    v_xor_b32 v9, 3, v8
    v_lshl_add_u32 v19, v9, 5, v5
    v_add_u32 v8, 2, v6
    v_and_b32 v8, 3, v8
    v_xor_b32 v9, 0, v8
    v_lshl_add_u32 v20, v9, 5, v5
    v_xor_b32 v9, 1, v8
    v_lshl_add_u32 v21, v9, 5, v5
    v_xor_b32 v9, 2, v8
    v_lshl_add_u32 v22, v9, 5, v5
    v_xor_b32 v9, 3, v8
    v_lshl_add_u32 v23, v9, 5, v5
    s_and_b32 s54, s35, 3
    s_lshl_b32 s63, s46, 1
    s_xor_b32 s55, s34, 1
    s_add_u32 s63, s63, s55
    s_lshl_b32 s63, s63, 2
    s_add_u32 s63, s63, s54
    s_lshl_b32 s64, s63, 14
    s_lshl_b32 s53, s52, 13
    s_add_u32 s64, s64, s53
    s_lshr_b32 s65, s63, 1
    s_lshl_b32 s65, s65, 8
    s_add_u32 s65, s65, 6307840
    s_lshl_b32 s66, s52, 3
    v_and_b32 v6, 1, v2
    v_lshlrev_b32 v6, 9, v6
    v_lshl_add_u32 v6, v1, 2, v6
    v_lshlrev_b32 v7, 2, v1
    s_nop 1
    s_branch L_P2
L_KV:
    s_cmp_eq_u32 s52, 0
    s_cbranch_scc1 L_KV_COMP
    s_mul_i32 s58, s51, 8192
    s_lshl_b32 s53, s50, 12
    s_add_u32 s58, s58, s53
    s_and_b32 s59, s35, 3
    s_lshl_b32 s59, s59, 11
    s_add_u32 s59, s59, 16384
    s_mov_b32 s68, 32768
    s_mov_b32 s69, 98304
    s_mov_b32 s61, 0
    s_cmp_lg_u32 s35, 7
    s_cbranch_scc1 L_NOGATE_K
    s_mov_b32 m0, 98304
    s_nop 0
    buffer_load_dwordx4 v11, s[24:27], 0 offen lds
L_NOGATE_K:
    s_lshl_b32 s62, s60, 7
    s_add_u32 s62, s62, s55
    s_mul_i32 s64, s60, 172032
    s_add_u32 s64, s64, s87
    s_add_u32 s60, s60, 1
    s_cmp_eq_u32 s60, 7
    s_cselect_b32 s60, 0, s60
    s_add_u32 s65, s58, s61
    s_add_u32 s56, s59, s61
    s_add_u32 m0, s65, 0
    s_nop 0
    buffer_load_dwordx4 v16, s[8:11], s62 offen lds
    s_add_u32 m0, s65, 1024
    s_nop 0
    buffer_load_dwordx4 v17, s[8:11], s62 offen lds
    s_add_u32 m0, s65, 2048
    s_nop 0
    buffer_load_dwordx4 v18, s[8:11], s62 offen lds
    s_add_u32 m0, s65, 3072
    s_nop 0
    buffer_load_dwordx4 v19, s[8:11], s62 offen lds
    s_add_u32 s66, s64, 896
    s_add_u32 m0, s56, 0
    s_nop 0
    buffer_load_dwordx4 v20, s[92:95], s66 offen lds
    s_add_u32 m0, s56, 1024
    s_nop 0
    buffer_load_dwordx4 v21, s[92:95], s66 offen lds
    s_add_u32 s66, s64, 1792
    s_add_u32 m0, s56, 8192
    s_nop 0
    buffer_load_dwordx4 v20, s[92:95], s66 offen lds
    s_add_u32 m0, s56, 9216
    s_nop 0
    buffer_load_dwordx4 v21, s[92:95], s66 offen lds
    s_add_u32 s61, s61, s68
    s_cmp_eq_u32 s61, s69
    s_cselect_b32 s61, 0, s61
    s_lshl_b32 s62, s60, 7
    s_add_u32 s62, s62, s55
    s_mul_i32 s64, s60, 172032
    s_add_u32 s64, s64, s87
    s_add_u32 s60, s60, 1
    s_cmp_eq_u32 s60, 7
    s_cselect_b32 s60, 0, s60
    s_add_u32 s65, s58, s61
    s_add_u32 s56, s59, s61
    s_add_u32 m0, s65, 0
    s_nop 0
    buffer_load_dwordx4 v16, s[8:11], s62 offen lds
    s_add_u32 m0, s65, 1024
    s_nop 0
    buffer_load_dwordx4 v17, s[8:11], s62 offen lds
    s_add_u32 m0, s65, 2048
    s_nop 0
    buffer_load_dwordx4 v18, s[8:11], s62 offen lds
    s_add_u32 m0, s65, 3072
    s_nop 0
    buffer_load_dwordx4 v19, s[8:11], s62 offen lds
    s_add_u32 s66, s64, 896
    s_add_u32 m0, s56, 0
    s_nop 0
    buffer_load_dwordx4 v20, s[92:95], s66 offen lds
    s_add_u32 m0, s56, 1024
    s_nop 0
    buffer_load_dwordx4 v21, s[92:95], s66 offen lds
    s_add_u32 s66, s64, 1792
    s_add_u32 m0, s56, 8192
    s_nop 0
    buffer_load_dwordx4 v20, s[92:95], s66 offen lds
    s_add_u32 m0, s56, 9216
    s_nop 0
    buffer_load_dwordx4 v21, s[92:95], s66 offen lds
    s_add_u32 s61, s61, s68
    s_cmp_eq_u32 s61, s69
    s_cselect_b32 s61, 0, s61
    s_mov_b32 s67, 0
L_LD_K:
    s_waitcnt vmcnt(8)
    s_barrier
    s_lshl_b32 s62, s60, 7
    s_add_u32 s62, s62, s55
    s_mul_i32 s64, s60, 172032
    s_add_u32 s64, s64, s87
    s_add_u32 s60, s60, 1
    s_cmp_eq_u32 s60, 7
    s_cselect_b32 s60, 0, s60
    s_add_u32 s65, s58, s61
    s_add_u32 s56, s59, s61
    s_add_u32 m0, s65, 0
    s_nop 0
    buffer_load_dwordx4 v16, s[8:11], s62 offen lds
    s_add_u32 m0, s65, 1024
    s_nop 0
    buffer_load_dwordx4 v17, s[8:11], s62 offen lds
    s_add_u32 m0, s65, 2048
    s_nop 0
    buffer_load_dwordx4 v18, s[8:11], s62 offen lds
    s_add_u32 m0, s65, 3072
    s_nop 0
    buffer_load_dwordx4 v19, s[8:11], s62 offen lds
    s_add_u32 s66, s64, 896
    s_add_u32 m0, s56, 0
    s_nop 0
    buffer_load_dwordx4 v20, s[92:95], s66 offen lds
    s_add_u32 m0, s56, 1024
    s_nop 0
    buffer_load_dwordx4 v21, s[92:95], s66 offen lds
    s_add_u32 s66, s64, 1792
    s_add_u32 m0, s56, 8192
    s_nop 0
    buffer_load_dwordx4 v20, s[92:95], s66 offen lds
    s_add_u32 m0, s56, 9216
    s_nop 0
    buffer_load_dwordx4 v21, s[92:95], s66 offen lds
    s_add_u32 s61, s61, s68
    s_cmp_eq_u32 s61, s69
    s_cselect_b32 s61, 0, s61
    s_add_u32 s67, s67, 1
    s_cmp_lt_u32 s67, 5
    s_cbranch_scc1 L_LD_K
    s_waitcnt vmcnt(8)
    s_barrier
    s_lshl_b32 s53, s33, 1
    s_add_u32 s53, s53, s50
    s_mul_i32 s53, s53, 1568
    v_mul_u32_u24 v5, 224, v2
    v_lshl_add_u32 v3, v1, 1, v5
    v_add_u32 v6, 16, v1
    v_min_u32 v6, 27, v6
    v_lshl_add_u32 v6, v6, 1, v5
    buffer_load_ushort v224, v3, s[20:23], s53 offen offset:0
    buffer_load_ushort v225, v3, s[20:23], s53 offen offset:56
    buffer_load_ushort v226, v3, s[20:23], s53 offen offset:112
    buffer_load_ushort v227, v3, s[20:23], s53 offen offset:168
    buffer_load_ushort v228, v3, s[20:23], s53 offen offset:896
    buffer_load_ushort v229, v3, s[20:23], s53 offen offset:952
    buffer_load_ushort v230, v3, s[20:23], s53 offen offset:1008
    buffer_load_ushort v231, v3, s[20:23], s53 offen offset:1064
    buffer_load_ushort v232, v6, s[20:23], s53 offen offset:0
    buffer_load_ushort v233, v6, s[20:23], s53 offen offset:56
    buffer_load_ushort v234, v6, s[20:23], s53 offen offset:112
    buffer_load_ushort v235, v6, s[20:23], s53 offen offset:168
    buffer_load_ushort v236, v6, s[20:23], s53 offen offset:896
    buffer_load_ushort v237, v6, s[20:23], s53 offen offset:952
    buffer_load_ushort v238, v6, s[20:23], s53 offen offset:1008
    buffer_load_ushort v239, v6, s[20:23], s53 offen offset:1064
    v_cmp_le_u32 s[84:85], 48, v0
    v_mov_b32 v10, 0xff800000
    v_mov_b32 v12, 0x3f803f80
    v_mov_b32 v13, 0x3f803f80
    v_mov_b32 v14, 0x3f803f80
    v_mov_b32 v15, 0x3f803f80
    s_and_b32 s53, s35, 3
    s_mul_i32 s53, s53, 2048
    s_add_u32 s53, s53, 100352
    v_add_u32 v251, s53, v11
    s_mov_b32 s90, 0x3fb8aa3b
    v_cmp_eq_u32 s[88:89], 12, v1
    s_lshl_b32 s36, s33, 4
    s_add_u32 s36, s36, s32
    s_lshl_b32 s36, s36, 3
    s_add_u32 s36, s36, s35
    s_lshl_b32 s36, s36, 10
    s_add_u32 s36, s36, 5242880
    s_lshl_b32 s37, s33, 3
    s_add_u32 s37, s37, s35
    s_lshl_b32 s37, s37, 8
    s_lshl_b32 s54, s32, 2
    s_add_u32 s37, s37, s54
    s_add_u32 s37, s37, 6291456
    v_lshrrev_b32 v248, 3, v0
    v_and_b32 v255, 6, v248
    v_mul_u32_u24 v248, 896, v248
    v_xor_b32 v255, v0, v255
    v_and_b32 v255, 7, v255
    v_lshl_add_u32 v248, v255, 4, v248
    s_mul_i32 s53, s35, 50176
    s_lshl_b32 s54, s47, 7
    s_add_u32 s53, s53, s54
    v_add_u32 v248, s53, v248
    s_mul_i32 s44, s35, 7168
    s_and_b32 s4, s2, 7
    s_and_b32 s53, s45, 1
    s_lshl_b32 s53, s53, 1
    s_add_u32 s53, s53, s50
    s_lshr_b32 s5, s53, 1
    s_and_b32 s6, s53, 1
    s_lshl_b32 s38, s6, 2
    s_add_u32 s38, s38, s5
    s_lshl_b32 s39, s4, 17
    s_lshl_b32 s40, s38, 10
    s_add_u32 s39, s39, s40
    s_add_u32 s39, s39, 5242880
    s_lshl_b32 s40, s4, 3
    s_add_u32 s38, s38, s40
    s_lshl_b32 s38, s38, 8
    s_add_u32 s38, s38, 6291456
    s_lshl_b32 s40, s4, 1
    s_add_u32 s40, s40, s5
    s_lshl_b32 s40, s40, 12
    s_lshl_b32 s41, s6, 11
    s_add_u32 s40, s40, s41
    s_add_u32 s40, s40, 4718592
    s_lshl_b32 s41, s4, 8
    s_lshl_b32 s53, s53, 2
    s_add_u32 s41, s41, s53
    s_add_u32 s41, s41, 6344704
    v_mov_b32 v252, 0
    buffer_load_dword v254, v252, s[28:31], 0 offen sc1
    v_mov_b32 v100, -1
    v_mov_b32 v101, -1
    v_mov_b32 v102, -1
    v_mov_b32 v103, -1
    s_sub_u32 s53, s36, 4096
    buffer_store_dwordx4 v[100:103], v11, s[16:19], s36 offen sc1
    buffer_store_dwordx4 v[100:103], v11, s[16:19], s53 offen sc1
    s_cmp_lt_u32 s45, 14
    s_nop 0
    s_cbranch_scc1 L_NC_K
    s_cmp_ge_u32 s35, 6
    s_cbranch_scc1 L_NC_K
    buffer_store_dwordx4 v[100:103], v11, s[16:19], s40 offen sc1
    buffer_store_dwordx4 v[100:103], v11, s[16:19], s40 offen offset:1024 sc1
    s_nop 1
L_NC_K:
    s_waitcnt vmcnt(19)
    s_barrier
    s_waitcnt vmcnt(0)
    v_lshl_or_b32 v240, v225, 16, v224
    v_lshl_or_b32 v241, v227, 16, v226
    v_lshl_or_b32 v242, v229, 16, v228
    v_lshl_or_b32 v243, v231, 16, v230
    v_cndmask_b32_e64 v242, v242, 0, s[84:85]
    v_cndmask_b32_e64 v243, v243, 0, s[84:85]
    v_lshl_or_b32 v244, v233, 16, v232
    v_lshl_or_b32 v245, v235, 16, v234
    v_lshl_or_b32 v246, v237, 16, v236
    v_lshl_or_b32 v247, v239, 16, v238
    v_cndmask_b32_e64 v246, v246, 0, s[84:85]
    v_cndmask_b32_e64 v247, v247, 0, s[84:85]
    s_lshr_b32 s53, s35, 1
    s_lshl_b32 s54, s50, 13
    s_add_u32 s54, s54, 147456
    v_add_u32 v21, s54, v11
    s_lshl_b32 s62, s51, 11
    v_add_u32 v22, s62, v21
    v_lshrrev_b32 v6, 1, v1
    v_and_b32 v6, 3, v6
    v_lshlrev_b32 v6, 5, v6
    v_lshl_add_u32 v6, v2, 3, v6
    v_lshl_add_u32 v16, v1, 7, v6
    s_lshl_b32 s54, s50, 14
    s_add_u32 s54, s54, 114688
    s_lshl_b32 s62, s53, 12
    s_add_u32 s62, s62, s54
    v_add_u32 v16, s62, v16
    v_xor_b32 v17, 32, v16
    v_xor_b32 v18, 64, v16
    v_xor_b32 v19, 96, v16
    v_lshrrev_b32 v6, 2, v1
    v_lshl_add_u32 v6, v2, 2, v6
    v_lshrrev_b32 v7, 1, v6
    v_and_b32 v7, 3, v7
    v_xor_b32 v7, s53, v7
    v_lshlrev_b32 v7, 5, v7
    v_lshl_add_u32 v20, v6, 7, v7
    v_and_b32 v7, 3, v0
    v_lshl_add_u32 v20, v7, 3, v20
    v_add_u32 v20, s54, v20
    s_mov_b32 s3, 0
    s_nop 0
L_GN_4:
    v_readfirstlane_b32 s49, v254
    s_nop 0
    s_cmp_lg_u32 s49, 0
    s_nop 2
    s_cbranch_scc1 L_GNX_4
    s_sleep 2
    v_mov_b32 v252, 0
    buffer_load_dword v254, v252, s[28:31], 0 offen sc1
    s_waitcnt vmcnt(0)
    s_add_u32 s3, s3, 1
    s_cmp_lt_u32 s3, 200000
    s_cbranch_scc1 L_GN_4
L_GNX_4:
    v_mov_b32 v252, 0
    v_mov_b32 v255, s49
    s_mov_b64 exec, 1
    buffer_store_dword v255, v252, s[16:19], s37 offen sc1
    s_mov_b64 exec, -1
    s_sub_u32 s53, s37, 1024
    v_mov_b32 v252, 0
    v_mov_b32 v255, s49
    s_mov_b64 exec, 1
    buffer_store_dword v255, v252, s[16:19], s53 offen sc1
    s_mov_b64 exec, -1
    s_cmp_lt_u32 s45, 14
    s_cbranch_scc1 L_NKRF
    s_cmp_ge_u32 s35, 6
    s_cbranch_scc1 L_NKRF
    v_mov_b32 v252, 0
    v_mov_b32 v255, s49
    s_mov_b64 exec, 1
    buffer_store_dword v255, v252, s[16:19], s41 offen sc1
    s_mov_b64 exec, -1
L_NKRF:
    s_barrier
    s_barrier
    ds_read_b128 v[24:27], v251
    ds_read_b128 v[28:31], v251 offset:1024
    s_waitcnt lgkmcnt(0)
    s_branch L_KV_EPI
L_KV_COMP:
    s_cmp_lg_u32 s2, 255
    s_cbranch_scc1 L_NOSCAN
    s_cmp_lg_u32 s35, 3
    s_cbranch_scc1 L_NOSCAN
    v_lshrrev_b32 v3, 2, v0
    v_lshlrev_b32 v3, 8, v3
    v_and_b32 v4, 3, v0
    v_lshl_add_u32 v3, v4, 4, v3
    s_mov_b32 s53, 6291456
    buffer_load_dwordx4 v[100:103], v3, s[16:19], s53 offen sc1
    s_add_u32 s53, s53, 4096
    buffer_load_dwordx4 v[104:107], v3, s[16:19], s53 offen sc1
    s_add_u32 s53, s53, 4096
    buffer_load_dwordx4 v[108:111], v3, s[16:19], s53 offen sc1
    s_add_u32 s53, s53, 4096
    buffer_load_dwordx4 v[112:115], v3, s[16:19], s53 offen sc1
    s_add_u32 s53, s53, 4096
    buffer_load_dwordx4 v[116:119], v3, s[16:19], s53 offen sc1
    s_add_u32 s53, s53, 4096
    buffer_load_dwordx4 v[120:123], v3, s[16:19], s53 offen sc1
    s_add_u32 s53, s53, 4096
    buffer_load_dwordx4 v[124:127], v3, s[16:19], s53 offen sc1
    s_add_u32 s53, s53, 4096
    buffer_load_dwordx4 v[128:131], v3, s[16:19], s53 offen sc1
    s_add_u32 s53, s53, 4096
    buffer_load_dwordx4 v[132:135], v3, s[16:19], s53 offen sc1
    s_add_u32 s53, s53, 4096
    buffer_load_dwordx4 v[136:139], v3, s[16:19], s53 offen sc1
    s_add_u32 s53, s53, 4096
    buffer_load_dwordx4 v[140:143], v3, s[16:19], s53 offen sc1
    s_add_u32 s53, s53, 4096
    buffer_load_dwordx4 v[144:147], v3, s[16:19], s53 offen sc1
    s_add_u32 s53, s53, 4096
    buffer_load_dwordx4 v[148:151], v3, s[16:19], s53 offen sc1
    s_add_u32 s53, s53, 4096
    buffer_load_dwordx4 v[152:155], v3, s[16:19], s53 offen sc1
    s_add_u32 s53, s53, 4096
    s_memrealtime s[88:89]
    s_waitcnt vmcnt(0) lgkmcnt(0)
    s_or_b32 s88, s88, 1
L_SCAN:
    s_mov_b64 s[90:91], 0
    v_cmp_eq_u32 vcc, s88, v100
    s_nop 0
    s_or_b64 s[90:91], s[90:91], vcc
    v_cmp_eq_u32 vcc, s88, v101
    s_nop 0
    s_or_b64 s[90:91], s[90:91], vcc
    v_cmp_eq_u32 vcc, s88, v102
    s_nop 0
    s_or_b64 s[90:91], s[90:91], vcc
    v_cmp_eq_u32 vcc, s88, v103
    s_nop 0
    s_or_b64 s[90:91], s[90:91], vcc
    v_cmp_eq_u32 vcc, s88, v104
    s_nop 0
    s_or_b64 s[90:91], s[90:91], vcc
    v_cmp_eq_u32 vcc, s88, v105
    s_nop 0
    s_or_b64 s[90:91], s[90:91], vcc
    v_cmp_eq_u32 vcc, s88, v106
    s_nop 0
    s_or_b64 s[90:91], s[90:91], vcc
    v_cmp_eq_u32 vcc, s88, v107
    s_nop 0
    s_or_b64 s[90:91], s[90:91], vcc
    v_cmp_eq_u32 vcc, s88, v108
    s_nop 0
    s_or_b64 s[90:91], s[90:91], vcc
    v_cmp_eq_u32 vcc, s88, v109
    s_nop 0
    s_or_b64 s[90:91], s[90:91], vcc
    v_cmp_eq_u32 vcc, s88, v110
    s_nop 0
    s_or_b64 s[90:91], s[90:91], vcc
    v_cmp_eq_u32 vcc, s88, v111
    s_nop 0
    s_or_b64 s[90:91], s[90:91], vcc
    v_cmp_eq_u32 vcc, s88, v112
    s_nop 0
    s_or_b64 s[90:91], s[90:91], vcc
    v_cmp_eq_u32 vcc, s88, v113
    s_nop 0
    s_or_b64 s[90:91], s[90:91], vcc
    v_cmp_eq_u32 vcc, s88, v114
    s_nop 0
    s_or_b64 s[90:91], s[90:91], vcc
    v_cmp_eq_u32 vcc, s88, v115
    s_nop 0
    s_or_b64 s[90:91], s[90:91], vcc
    v_cmp_eq_u32 vcc, s88, v116
    s_nop 0
    s_or_b64 s[90:91], s[90:91], vcc
    v_cmp_eq_u32 vcc, s88, v117
    s_nop 0
    s_or_b64 s[90:91], s[90:91], vcc
    v_cmp_eq_u32 vcc, s88, v118
    s_nop 0
    s_or_b64 s[90:91], s[90:91], vcc
    v_cmp_eq_u32 vcc, s88, v119
    s_nop 0
    s_or_b64 s[90:91], s[90:91], vcc
    v_cmp_eq_u32 vcc, s88, v120
    s_nop 0
    s_or_b64 s[90:91], s[90:91], vcc
    v_cmp_eq_u32 vcc, s88, v121
    s_nop 0
    s_or_b64 s[90:91], s[90:91], vcc
    v_cmp_eq_u32 vcc, s88, v122
    s_nop 0
    s_or_b64 s[90:91], s[90:91], vcc
    v_cmp_eq_u32 vcc, s88, v123
    s_nop 0
    s_or_b64 s[90:91], s[90:91], vcc
    v_cmp_eq_u32 vcc, s88, v124
    s_nop 0
    s_or_b64 s[90:91], s[90:91], vcc
    v_cmp_eq_u32 vcc, s88, v125
    s_nop 0
    s_or_b64 s[90:91], s[90:91], vcc
    v_cmp_eq_u32 vcc, s88, v126
    s_nop 0
    s_or_b64 s[90:91], s[90:91], vcc
    v_cmp_eq_u32 vcc, s88, v127
    s_nop 0
    s_or_b64 s[90:91], s[90:91], vcc
    v_cmp_eq_u32 vcc, s88, v128
    s_nop 0
    s_or_b64 s[90:91], s[90:91], vcc
    v_cmp_eq_u32 vcc, s88, v129
    s_nop 0
    s_or_b64 s[90:91], s[90:91], vcc
    v_cmp_eq_u32 vcc, s88, v130
    s_nop 0
    s_or_b64 s[90:91], s[90:91], vcc
    v_cmp_eq_u32 vcc, s88, v131
    s_nop 0
    s_or_b64 s[90:91], s[90:91], vcc
    v_cmp_eq_u32 vcc, s88, v132
    s_nop 0
    s_or_b64 s[90:91], s[90:91], vcc
    v_cmp_eq_u32 vcc, s88, v133
    s_nop 0
    s_or_b64 s[90:91], s[90:91], vcc
    v_cmp_eq_u32 vcc, s88, v134
    s_nop 0
    s_or_b64 s[90:91], s[90:91], vcc
    v_cmp_eq_u32 vcc, s88, v135
    s_nop 0
    s_or_b64 s[90:91], s[90:91], vcc
    v_cmp_eq_u32 vcc, s88, v136
    s_nop 0
    s_or_b64 s[90:91], s[90:91], vcc
    v_cmp_eq_u32 vcc, s88, v137
    s_nop 0
    s_or_b64 s[90:91], s[90:91], vcc
    v_cmp_eq_u32 vcc, s88, v138
    s_nop 0
    s_or_b64 s[90:91], s[90:91], vcc
    v_cmp_eq_u32 vcc, s88, v139
    s_nop 0
    s_or_b64 s[90:91], s[90:91], vcc
    v_cmp_eq_u32 vcc, s88, v140
    s_nop 0
    s_or_b64 s[90:91], s[90:91], vcc
    v_cmp_eq_u32 vcc, s88, v141
    s_nop 0
    s_or_b64 s[90:91], s[90:91], vcc
    v_cmp_eq_u32 vcc, s88, v142
    s_nop 0
    s_or_b64 s[90:91], s[90:91], vcc
    v_cmp_eq_u32 vcc, s88, v143
    s_nop 0
    s_or_b64 s[90:91], s[90:91], vcc
    v_cmp_eq_u32 vcc, s88, v144
    s_nop 0
    s_or_b64 s[90:91], s[90:91], vcc
    v_cmp_eq_u32 vcc, s88, v145
    s_nop 0
    s_or_b64 s[90:91], s[90:91], vcc
    v_cmp_eq_u32 vcc, s88, v146
    s_nop 0
    s_or_b64 s[90:91], s[90:91], vcc
    v_cmp_eq_u32 vcc, s88, v147
    s_nop 0
    s_or_b64 s[90:91], s[90:91], vcc
    v_cmp_eq_u32 vcc, s88, v148
    s_nop 0
    s_or_b64 s[90:91], s[90:91], vcc
    v_cmp_eq_u32 vcc, s88, v149
    s_nop 0
    s_or_b64 s[90:91], s[90:91], vcc
    v_cmp_eq_u32 vcc, s88, v150
    s_nop 0
    s_or_b64 s[90:91], s[90:91], vcc
    v_cmp_eq_u32 vcc, s88, v151
    s_nop 0
    s_or_b64 s[90:91], s[90:91], vcc
    v_cmp_eq_u32 vcc, s88, v152
    s_nop 0
    s_or_b64 s[90:91], s[90:91], vcc
    v_cmp_eq_u32 vcc, s88, v153
    s_nop 0
    s_or_b64 s[90:91], s[90:91], vcc
    v_cmp_eq_u32 vcc, s88, v154
    s_nop 0
    s_or_b64 s[90:91], s[90:91], vcc
    v_cmp_eq_u32 vcc, s88, v155
    s_nop 0
    s_or_b64 s[90:91], s[90:91], vcc
    s_cmp_eq_u64 s[90:91], 0
    s_nop 1
    s_cbranch_scc1 L_SCANOK
    s_add_u32 s88, s88, 2
    s_branch L_SCAN
L_SCANOK:
    v_mov_b32 v3, 0
    v_mov_b32 v5, s88
    s_mov_b64 exec, 1
    buffer_store_dword v5, v3, s[28:31], 0 offen sc1
    s_mov_b64 exec, -1
L_NOSCAN:
    s_and_b32 s53, s2, 127
    s_mul_i32 s53, s53, 3136
    s_lshl_b32 s54, s35, 10
    s_add_u32 s53, s53, s54
    buffer_load_dwordx4 v[200:203], v11, s[76:79], s53 offen
    s_lshl_b32 s53, s33, 1
    s_add_u32 s53, s53, s50
    s_mul_i32 s53, s53, 1568
    v_mul_u32_u24 v5, 224, v2
    v_lshl_add_u32 v3, v1, 1, v5
    v_add_u32 v6, 16, v1
    v_min_u32 v6, 27, v6
    v_lshl_add_u32 v6, v6, 1, v5
    buffer_load_ushort v224, v3, s[20:23], s53 offen offset:0
    buffer_load_ushort v225, v3, s[20:23], s53 offen offset:56
    buffer_load_ushort v226, v3, s[20:23], s53 offen offset:112
    buffer_load_ushort v227, v3, s[20:23], s53 offen offset:168
    buffer_load_ushort v228, v3, s[20:23], s53 offen offset:896
    buffer_load_ushort v229, v3, s[20:23], s53 offen offset:952
    buffer_load_ushort v230, v3, s[20:23], s53 offen offset:1008
    buffer_load_ushort v231, v3, s[20:23], s53 offen offset:1064
    buffer_load_ushort v232, v6, s[20:23], s53 offen offset:0
    buffer_load_ushort v233, v6, s[20:23], s53 offen offset:56
    buffer_load_ushort v234, v6, s[20:23], s53 offen offset:112
    buffer_load_ushort v235, v6, s[20:23], s53 offen offset:168
    buffer_load_ushort v236, v6, s[20:23], s53 offen offset:896
    buffer_load_ushort v237, v6, s[20:23], s53 offen offset:952
    buffer_load_ushort v238, v6, s[20:23], s53 offen offset:1008
    buffer_load_ushort v239, v6, s[20:23], s53 offen offset:1064
    v_cmp_le_u32 s[84:85], 48, v0
    v_mov_b32 v10, 0xff800000
    v_mov_b32 v12, 0x3f803f80
    v_mov_b32 v13, 0x3f803f80
    v_mov_b32 v14, 0x3f803f80
    v_mov_b32 v15, 0x3f803f80
    s_and_b32 s53, s35, 3
    s_mul_i32 s53, s53, 2048
    s_add_u32 s53, s53, 100352
    v_add_u32 v251, s53, v11
    s_mov_b32 s90, 0x3fb8aa3b
    v_cmp_eq_u32 s[88:89], 12, v1
    s_lshl_b32 s36, s33, 4
    s_add_u32 s36, s36, s32
    s_lshl_b32 s36, s36, 3
    s_add_u32 s36, s36, s35
    s_lshl_b32 s36, s36, 10
    s_add_u32 s36, s36, 5242880
    s_lshl_b32 s37, s33, 3
    s_add_u32 s37, s37, s35
    s_lshl_b32 s37, s37, 8
    s_lshl_b32 s54, s32, 2
    s_add_u32 s37, s37, s54
    s_add_u32 s37, s37, 6291456
    v_lshrrev_b32 v248, 3, v0
    v_and_b32 v255, 6, v248
    v_mul_u32_u24 v248, 896, v248
    v_xor_b32 v255, v0, v255
    v_and_b32 v255, 7, v255
    v_lshl_add_u32 v248, v255, 4, v248
    s_mul_i32 s53, s35, 50176
    s_lshl_b32 s54, s47, 7
    s_add_u32 s53, s53, s54
    v_add_u32 v248, s53, v248
    s_mul_i32 s44, s35, 7168
    s_and_b32 s4, s2, 7
    s_and_b32 s53, s45, 1
    s_lshl_b32 s53, s53, 1
    s_add_u32 s53, s53, s50
    s_lshr_b32 s5, s53, 1
    s_and_b32 s6, s53, 1
    s_lshl_b32 s38, s6, 2
    s_add_u32 s38, s38, s5
    s_lshl_b32 s39, s4, 17
    s_lshl_b32 s40, s38, 10
    s_add_u32 s39, s39, s40
    s_add_u32 s39, s39, 5242880
    s_lshl_b32 s40, s4, 3
    s_add_u32 s38, s38, s40
    s_lshl_b32 s38, s38, 8
    s_add_u32 s38, s38, 6291456
    s_lshl_b32 s40, s4, 1
    s_add_u32 s40, s40, s5
    s_lshl_b32 s40, s40, 12
    s_lshl_b32 s41, s6, 11
    s_add_u32 s40, s40, s41
    s_add_u32 s40, s40, 4718592
    s_lshl_b32 s41, s4, 8
    s_lshl_b32 s53, s53, 2
    s_add_u32 s41, s41, s53
    s_add_u32 s41, s41, 6344704
    v_lshrrev_b32 v3, 2, v1
    v_and_b32 v16, 3, v0
    v_lshl_add_u32 v17, v2, 3, v3
    v_lshlrev_b32 v17, 7, v17
    v_lshrrev_b32 v18, 1, v3
    v_lshlrev_b32 v18, 1, v18
    v_and_b32 v19, 1, v2
    v_lshl_add_u32 v18, v19, 2, v18
    s_mul_i32 s53, s50, 56
    v_lshlrev_b32 v19, 3, v16
    v_add_u32 v19, s53, v19
    v_lshrrev_b32 v20, 4, v19
    v_xor_b32 v20, v20, v18
    v_lshlrev_b32 v20, 4, v20
    v_and_b32 v21, 8, v19
    v_add3_u32 v8, v17, v20, v21
    v_add_u32 v8, 16384, v8
    v_add_u32 v19, 32, v19
    v_lshrrev_b32 v20, 4, v19
    v_xor_b32 v20, v20, v18
    v_lshlrev_b32 v20, 4, v20
    v_and_b32 v21, 8, v19
    v_add3_u32 v9, v17, v20, v21
    v_add_u32 v9, 16384, v9
    v_lshrrev_b32 v3, 1, v1
    v_xor_b32 v4, v2, v3
    v_lshlrev_b32 v4, 4, v4
    v_lshl_add_u32 v4, v1, 7, v4
    s_mul_i32 s53, s51, 8192
    v_add_u32 v4, s53, v4
    v_xor_b32 v5, 64, v4
    s_waitcnt vmcnt(0)
    v_lshl_or_b32 v240, v225, 16, v224
    v_lshl_or_b32 v241, v227, 16, v226
    v_lshl_or_b32 v242, v229, 16, v228
    v_lshl_or_b32 v243, v231, 16, v230
    v_cndmask_b32_e64 v242, v242, 0, s[84:85]
    v_cndmask_b32_e64 v243, v243, 0, s[84:85]
    v_lshl_or_b32 v244, v233, 16, v232
    v_lshl_or_b32 v245, v235, 16, v234
    v_lshl_or_b32 v246, v237, 16, v236
    v_lshl_or_b32 v247, v239, 16, v238
    v_cndmask_b32_e64 v246, v246, 0, s[84:85]
    v_cndmask_b32_e64 v247, v247, 0, s[84:85]
    s_lshr_b32 s53, s35, 1
    s_lshl_b32 s54, s50, 13
    s_add_u32 s54, s54, 147456
    v_add_u32 v21, s54, v11
    s_lshl_b32 s62, s51, 11
    v_add_u32 v22, s62, v21
    v_lshrrev_b32 v6, 1, v1
    v_and_b32 v6, 3, v6
    v_lshlrev_b32 v6, 5, v6
    v_lshl_add_u32 v6, v2, 3, v6
    v_lshl_add_u32 v16, v1, 7, v6
    s_lshl_b32 s54, s50, 14
    s_add_u32 s54, s54, 114688
    s_lshl_b32 s62, s53, 12
    s_add_u32 s62, s62, s54
    v_add_u32 v16, s62, v16
    v_xor_b32 v17, 32, v16
    v_xor_b32 v18, 64, v16
    v_xor_b32 v19, 96, v16
    v_lshrrev_b32 v6, 2, v1
    v_lshl_add_u32 v6, v2, 2, v6
    v_lshrrev_b32 v7, 1, v6
    v_and_b32 v7, 3, v7
    v_xor_b32 v7, s53, v7
    v_lshlrev_b32 v7, 5, v7
    v_lshl_add_u32 v20, v6, 7, v7
    v_and_b32 v7, 3, v0
    v_lshl_add_u32 v20, v7, 3, v20
    v_add_u32 v20, s54, v20
    s_lshl_b32 s53, s48, 7
    s_add_u32 s53, s53, 98304
    v_lshlrev_b32 v3, 4, v2
    v_add_u32 v3, s53, v3
    s_mov_b32 s71, s48
    v_mov_b32 v112, 0
    v_mov_b32 v113, 0
    v_mov_b32 v114, 0
    v_mov_b32 v115, 0
    v_mov_b32 v116, 0
    v_mov_b32 v117, 0
    v_mov_b32 v118, 0
    v_mov_b32 v119, 0
    v_mov_b32 v120, 0
    v_mov_b32 v121, 0
    v_mov_b32 v122, 0
    v_mov_b32 v123, 0
    v_mov_b32 v124, 0
    v_mov_b32 v125, 0
    v_mov_b32 v126, 0
    v_mov_b32 v127, 0
    v_mov_b32 v128, 0
    v_mov_b32 v129, 0
    v_mov_b32 v130, 0
    v_mov_b32 v131, 0
    v_mov_b32 v132, 0
    v_mov_b32 v133, 0
    v_mov_b32 v134, 0
    v_mov_b32 v135, 0
    v_mov_b32 v136, 0
    v_mov_b32 v137, 0
    v_mov_b32 v138, 0
    v_mov_b32 v139, 0
    v_mov_b32 v140, 0
    v_mov_b32 v141, 0
    v_mov_b32 v142, 0
    v_mov_b32 v143, 0
    v_mov_b32 v144, 0
    v_mov_b32 v145, 0
    v_mov_b32 v146, 0
    v_mov_b32 v147, 0
    v_mov_b32 v148, 0
    v_mov_b32 v149, 0
    v_mov_b32 v150, 0
    v_mov_b32 v151, 0
    v_mov_b32 v152, 0
    v_mov_b32 v153, 0
    v_mov_b32 v154, 0
    v_mov_b32 v155, 0
    v_mov_b32 v156, 0
    v_mov_b32 v157, 0
    v_mov_b32 v158, 0
    v_mov_b32 v159, 0
    v_mov_b32 v160, 0
    v_mov_b32 v161, 0
    v_mov_b32 v162, 0
    v_mov_b32 v163, 0
    v_mov_b32 v164, 0
    v_mov_b32 v165, 0
    v_mov_b32 v166, 0
    v_mov_b32 v167, 0
    v_mov_b32 v168, 0
    v_mov_b32 v169, 0
    v_mov_b32 v170, 0
    v_mov_b32 v171, 0
    v_mov_b32 v172, 0
    v_mov_b32 v173, 0
    v_mov_b32 v174, 0
    v_mov_b32 v175, 0
    v_mov_b32 v176, 0
    v_mov_b32 v177, 0
    v_mov_b32 v178, 0
    v_mov_b32 v179, 0
    v_mov_b32 v180, 0
    v_mov_b32 v181, 0
    v_mov_b32 v182, 0
    v_mov_b32 v183, 0
    v_mov_b32 v184, 0
    v_mov_b32 v185, 0
    v_mov_b32 v186, 0
    v_mov_b32 v187, 0
    v_mov_b32 v188, 0
    v_mov_b32 v189, 0
    v_mov_b32 v190, 0
    v_mov_b32 v191, 0
    s_mov_b32 s68, 32768
    s_mov_b32 s69, 4294901760
    s_movk_i32 s60, 128
    s_movk_i32 s61, -768
    s_mov_b32 s67, 0
    s_mov_b32 s70, 0
    s_barrier
    ds_read_b128 v[24:27], v4 offset:0
    ds_read_b128 v[28:31], v4 offset:2048
    ds_read_b128 v[32:35], v4 offset:4096
    ds_read_b128 v[36:39], v4 offset:6144
    ds_read_b64_tr_b16 v[44:45], v8 offset:0
    ds_read_b64_tr_b16 v[46:47], v8 offset:512
    ds_read_b64_tr_b16 v[48:49], v9 offset:0
    ds_read_b64_tr_b16 v[50:51], v9 offset:512
    ds_read_b64_tr_b16 v[52:53], v8 offset:8192
    ds_read_b64_tr_b16 v[54:55], v8 offset:8704
    ds_read_b64_tr_b16 v[56:57], v9 offset:8192
    ds_read_b64_tr_b16 v[58:59], v9 offset:8704
    ds_read_b128 v[40:43], v3 offset:0
L_CP_K:
    s_waitcnt lgkmcnt(0)
    v_mfma_f32_16x16x32_bf16 v[128:131], v[44:47], v[32:35], v[128:131]
    ds_read_b128 v[68:71], v5 offset:0
    v_mfma_f32_16x16x32_bf16 v[132:135], v[48:51], v[32:35], v[132:135]
    ds_read_b128 v[72:75], v5 offset:2048
    v_mfma_f32_16x16x32_bf16 v[136:139], v[44:47], v[36:39], v[136:139]
    ds_read_b128 v[76:79], v5 offset:4096
    v_mfma_f32_16x16x32_bf16 v[140:143], v[48:51], v[36:39], v[140:143]
    ds_read_b128 v[80:83], v5 offset:6144
    v_mfma_f32_16x16x32_bf16 v[112:115], v[44:47], v[24:27], v[112:115]
    ds_read_b64_tr_b16 v[88:89], v8 offset:4096
    v_mfma_f32_16x16x32_bf16 v[116:119], v[48:51], v[24:27], v[116:119]
    ds_read_b64_tr_b16 v[90:91], v8 offset:4608
    v_mfma_f32_16x16x32_bf16 v[120:123], v[44:47], v[28:31], v[120:123]
    ds_read_b64_tr_b16 v[92:93], v9 offset:4096
    v_mfma_f32_16x16x32_bf16 v[124:127], v[48:51], v[28:31], v[124:127]
    ds_read_b64_tr_b16 v[94:95], v9 offset:4608
    v_mfma_f32_16x16x32_bf16 v[144:147], v[24:27], v[52:55], v[144:147]
    ds_read_b64_tr_b16 v[96:97], v8 offset:12288
    v_mfma_f32_16x16x32_bf16 v[148:151], v[24:27], v[56:59], v[148:151]
    ds_read_b64_tr_b16 v[98:99], v8 offset:12800
    v_mfma_f32_16x16x32_bf16 v[152:155], v[28:31], v[52:55], v[152:155]
    ds_read_b64_tr_b16 v[100:101], v9 offset:12288
    v_mfma_f32_16x16x32_bf16 v[156:159], v[28:31], v[56:59], v[156:159]
    ds_read_b64_tr_b16 v[102:103], v9 offset:12800
    v_mfma_f32_16x16x32_bf16 v[160:163], v[32:35], v[52:55], v[160:163]
    ds_read_b128 v[84:87], v3 offset:64
    v_mfma_f32_16x16x32_bf16 v[164:167], v[32:35], v[56:59], v[164:167]
    v_mfma_f32_16x16x32_bf16 v[168:171], v[36:39], v[52:55], v[168:171]
    v_mfma_f32_16x16x32_bf16 v[172:175], v[36:39], v[56:59], v[172:175]
    v_mfma_f32_16x16x32_bf16 v[176:179], v[40:43], v[24:27], v[176:179]
    v_mfma_f32_16x16x32_bf16 v[180:183], v[40:43], v[28:31], v[180:183]
    v_mfma_f32_16x16x32_bf16 v[184:187], v[40:43], v[32:35], v[184:187]
    v_mfma_f32_16x16x32_bf16 v[188:191], v[40:43], v[36:39], v[188:191]
    s_add_u32 s70, s70, 1
    s_cmp_eq_u32 s70, 3
    s_cselect_b32 s53, s69, s68
    s_cselect_b32 s70, 0, s70
    s_waitcnt lgkmcnt(0)
    v_add_u32 v4, s53, v4
    v_add_u32 v5, s53, v5
    v_add_u32 v8, s53, v8
    v_add_u32 v9, s53, v9
    s_add_u32 s71, s71, 1
    s_cmp_eq_u32 s71, 7
    s_cselect_b32 s53, s61, s60
    s_cselect_b32 s71, 0, s71
    v_add_u32 v3, s53, v3
    s_barrier
    v_mfma_f32_16x16x32_bf16 v[128:131], v[88:91], v[76:79], v[128:131]
    ds_read_b128 v[24:27], v4 offset:0
    v_mfma_f32_16x16x32_bf16 v[132:135], v[92:95], v[76:79], v[132:135]
    ds_read_b128 v[28:31], v4 offset:2048
    v_mfma_f32_16x16x32_bf16 v[136:139], v[88:91], v[80:83], v[136:139]
    ds_read_b128 v[32:35], v4 offset:4096
    v_mfma_f32_16x16x32_bf16 v[140:143], v[92:95], v[80:83], v[140:143]
    ds_read_b128 v[36:39], v4 offset:6144
    v_mfma_f32_16x16x32_bf16 v[112:115], v[88:91], v[68:71], v[112:115]
    ds_read_b64_tr_b16 v[44:45], v8 offset:0
    v_mfma_f32_16x16x32_bf16 v[116:119], v[92:95], v[68:71], v[116:119]
    ds_read_b64_tr_b16 v[46:47], v8 offset:512
    v_mfma_f32_16x16x32_bf16 v[120:123], v[88:91], v[72:75], v[120:123]
    ds_read_b64_tr_b16 v[48:49], v9 offset:0
    v_mfma_f32_16x16x32_bf16 v[124:127], v[92:95], v[72:75], v[124:127]
    ds_read_b64_tr_b16 v[50:51], v9 offset:512
    v_mfma_f32_16x16x32_bf16 v[144:147], v[68:71], v[96:99], v[144:147]
    ds_read_b64_tr_b16 v[52:53], v8 offset:8192
    v_mfma_f32_16x16x32_bf16 v[148:151], v[68:71], v[100:103], v[148:151]
    ds_read_b64_tr_b16 v[54:55], v8 offset:8704
    v_mfma_f32_16x16x32_bf16 v[152:155], v[72:75], v[96:99], v[152:155]
    ds_read_b64_tr_b16 v[56:57], v9 offset:8192
    v_mfma_f32_16x16x32_bf16 v[156:159], v[72:75], v[100:103], v[156:159]
    ds_read_b64_tr_b16 v[58:59], v9 offset:8704
    v_mfma_f32_16x16x32_bf16 v[160:163], v[76:79], v[96:99], v[160:163]
    ds_read_b128 v[40:43], v3 offset:0
    v_mfma_f32_16x16x32_bf16 v[164:167], v[76:79], v[100:103], v[164:167]
    v_mfma_f32_16x16x32_bf16 v[168:171], v[80:83], v[96:99], v[168:171]
    v_mfma_f32_16x16x32_bf16 v[172:175], v[80:83], v[100:103], v[172:175]
    v_mfma_f32_16x16x32_bf16 v[176:179], v[84:87], v[68:71], v[176:179]
    v_mfma_f32_16x16x32_bf16 v[180:183], v[84:87], v[72:75], v[180:183]
    v_mfma_f32_16x16x32_bf16 v[184:187], v[84:87], v[76:79], v[184:187]
    v_mfma_f32_16x16x32_bf16 v[188:191], v[84:87], v[80:83], v[188:191]
    s_add_u32 s67, s67, 1
    s_cmp_lt_u32 s67, 7
    s_nop 5
    s_cbranch_scc1 L_CP_K
    s_waitcnt lgkmcnt(0)
    v_mov_b32 v252, 0
    buffer_load_dword v254, v252, s[28:31], 0 offen sc1
    v_cvt_pk_bf16_f32 v44, v128, v129
    v_cvt_pk_bf16_f32 v45, v130, v131
    v_cvt_pk_bf16_f32 v46, v132, v133
    v_cvt_pk_bf16_f32 v47, v134, v135
    ds_write_b128 v251, v[44:47] offset:0
    v_cvt_pk_bf16_f32 v48, v136, v137
    v_cvt_pk_bf16_f32 v49, v138, v139
    v_cvt_pk_bf16_f32 v50, v140, v141
    v_cvt_pk_bf16_f32 v51, v142, v143
    ds_write_b128 v251, v[48:51] offset:1024
    v_cvt_pk_bf16_f32 v24, v112, v113
    v_cvt_pk_bf16_f32 v25, v114, v115
    v_cvt_pk_bf16_f32 v26, v116, v117
    v_cvt_pk_bf16_f32 v27, v118, v119
    v_cvt_pk_bf16_f32 v28, v120, v121
    v_cvt_pk_bf16_f32 v29, v122, v123
    v_cvt_pk_bf16_f32 v30, v124, v125
    v_cvt_pk_bf16_f32 v31, v126, v127
    s_waitcnt lgkmcnt(0)
    s_barrier
    v_cvt_pk_bf16_f32 v44, v144, v145
    v_cvt_pk_bf16_f32 v45, v146, v147
    v_cvt_pk_bf16_f32 v46, v152, v153
    v_cvt_pk_bf16_f32 v47, v154, v155
    ds_write_b128 v22, v[44:47] offset:0
    v_cvt_pk_bf16_f32 v48, v148, v149
    v_cvt_pk_bf16_f32 v49, v150, v151
    v_cvt_pk_bf16_f32 v50, v156, v157
    v_cvt_pk_bf16_f32 v51, v158, v159
    v_cndmask_b32_e64 v48, v48, v12, s[88:89]
    v_cndmask_b32_e64 v49, v49, v12, s[88:89]
    v_cndmask_b32_e64 v50, v50, v12, s[88:89]
    v_cndmask_b32_e64 v51, v51, v12, s[88:89]
    ds_write_b128 v22, v[48:51] offset:1024
    v_cvt_pk_bf16_f32 v52, v160, v161
    v_cvt_pk_bf16_f32 v53, v162, v163
    v_cvt_pk_bf16_f32 v54, v168, v169
    v_cvt_pk_bf16_f32 v55, v170, v171
    ds_write_b128 v22, v[52:55] offset:4096
    v_cvt_pk_bf16_f32 v56, v164, v165
    v_cvt_pk_bf16_f32 v57, v166, v167
    v_cvt_pk_bf16_f32 v58, v172, v173
    v_cvt_pk_bf16_f32 v59, v174, v175
    v_cndmask_b32_e64 v56, v56, v12, s[88:89]
    v_cndmask_b32_e64 v57, v57, v12, s[88:89]
    v_cndmask_b32_e64 v58, v58, v12, s[88:89]
    v_cndmask_b32_e64 v59, v59, v12, s[88:89]
    ds_write_b128 v22, v[56:59] offset:5120
    s_or_b32 s53, s33, s50
    s_cmp_lg_u32 s53, 0
    s_cbranch_scc1 L_KV_EPI
    s_lshl_b32 s53, s32, 1
    s_add_u32 s53, s53, s51
    s_lshl_b32 s53, s53, 10
    s_add_u32 s53, s53, 4194304
    v_lshlrev_b32 v3, 2, v0
    v_mul_f32 v176, s90, v176
    v_exp_f32 v176, -v176
    s_nop 0
    v_add_f32 v176, 1.0, v176
    v_rcp_f32 v176, v176
    buffer_store_dword v176, v3, s[16:19], s53 offen offset:0 sc1
    v_mul_f32 v180, s90, v180
    v_exp_f32 v180, -v180
    s_nop 0
    v_add_f32 v180, 1.0, v180
    v_rcp_f32 v180, v180
    buffer_store_dword v180, v3, s[16:19], s53 offen offset:256 sc1
    v_mul_f32 v184, s90, v184
    v_exp_f32 v184, -v184
    s_nop 0
    v_add_f32 v184, 1.0, v184
    v_rcp_f32 v184, v184
    buffer_store_dword v184, v3, s[16:19], s53 offen offset:512 sc1
    v_mul_f32 v188, s90, v188
    v_exp_f32 v188, -v188
    s_nop 0
    v_add_f32 v188, 1.0, v188
    v_rcp_f32 v188, v188
    buffer_store_dword v188, v3, s[16:19], s53 offen offset:768 sc1
    s_nop 0
L_KV_EPI:
    v_mfma_f32_16x16x32_bf16 v[64:67], v[240:243], v[24:27], 0
    v_mfma_f32_16x16x32_bf16 v[68:71], v[244:247], v[24:27], 0
    v_mfma_f32_16x16x32_bf16 v[72:75], v[240:243], v[28:31], 0
    v_mfma_f32_16x16x32_bf16 v[76:79], v[244:247], v[28:31], 0
    s_nop 4
    v_max3_f32 v80, v64, v65, v66
    v_max3_f32 v80, v80, v67, v68
    v_max3_f32 v80, v80, v69, v70
    v_max_f32_e64 v80, v80, v71
    v_max3_f32 v82, -v64, -v65, -v66
    v_max3_f32 v82, v82, -v67, -v68
    v_max3_f32 v82, v82, -v69, -v70
    v_max_f32_e64 v82, v82, -v71
    v_max3_f32 v81, v72, v73, v74
    v_max3_f32 v81, v81, v75, v76
    v_max3_f32 v81, v81, v77, v78
    v_max_f32_e64 v81, v81, v79
    v_max3_f32 v83, -v72, -v73, -v74
    v_max3_f32 v83, v83, -v75, -v76
    v_max3_f32 v83, v83, -v77, -v78
    v_max_f32_e64 v83, v83, -v79
    v_permlane32_swap_b32 v80, v81
    s_nop 0
    v_permlane32_swap_b32 v82, v83
    v_max_f32 v80, v80, v81
    v_max_f32 v82, v82, v83
    s_nop 1
    v_permlane16_swap_b32 v80, v82
    v_max_f32 v80, v80, v82
    v_mov_b32 v82, v80
    s_nop 1
    v_permlane16_swap_b32 v80, v82
    v_mov_b32 v81, v80
    v_mov_b32 v83, v82
    s_nop 0
    v_permlane32_swap_b32 v80, v81
    v_permlane32_swap_b32 v82, v83
    v_mul_f32_e64 v80, -s90, v80
    v_cndmask_b32_e64 v84, v80, v10, s[84:85]
    v_mul_f32_e64 v81, -s90, v81
    v_cndmask_b32_e64 v85, v81, v10, s[84:85]
    v_mul_f32_e64 v82, -s90, v82
    v_cndmask_b32_e64 v86, v82, v10, s[84:85]
    v_mul_f32_e64 v83, -s90, v83
    v_cndmask_b32_e64 v87, v83, v10, s[84:85]
    v_fma_f32 v104, v64, s90, v80
    v_fma_f32 v105, v65, s90, v80
    v_fma_f32 v106, v66, s90, v80
    v_fma_f32 v107, v67, s90, v80
    v_fma_f32 v108, v68, s90, v84
    v_fma_f32 v109, v69, s90, v84
    v_fma_f32 v110, v70, s90, v84
    v_fma_f32 v111, v71, s90, v84
    v_exp_f32 v104, v104
    v_exp_f32 v105, v105
    v_exp_f32 v106, v106
    v_exp_f32 v107, v107
    v_exp_f32 v108, v108
    v_exp_f32 v109, v109
    v_exp_f32 v110, v110
    v_exp_f32 v111, v111
    v_cvt_pk_bf16_f32 v224, v104, v105
    v_cvt_pk_bf16_f32 v225, v106, v107
    v_cvt_pk_bf16_f32 v226, v108, v109
    v_cvt_pk_bf16_f32 v227, v110, v111
    s_nop 1
    v_mfma_f32_16x16x32_bf16 v[88:91], v[12:15], v[224:227], 0
    v_fma_f32 v112, v72, s90, v81
    v_fma_f32 v113, v73, s90, v81
    v_fma_f32 v114, v74, s90, v81
    v_fma_f32 v115, v75, s90, v81
    v_fma_f32 v116, v76, s90, v85
    v_fma_f32 v117, v77, s90, v85
    v_fma_f32 v118, v78, s90, v85
    v_fma_f32 v119, v79, s90, v85
    v_exp_f32 v112, v112
    v_exp_f32 v113, v113
    v_exp_f32 v114, v114
    v_exp_f32 v115, v115
    v_exp_f32 v116, v116
    v_exp_f32 v117, v117
    v_exp_f32 v118, v118
    v_exp_f32 v119, v119
    v_cvt_pk_bf16_f32 v228, v112, v113
    v_cvt_pk_bf16_f32 v229, v114, v115
    v_cvt_pk_bf16_f32 v230, v116, v117
    v_cvt_pk_bf16_f32 v231, v118, v119
    s_nop 1
    v_mfma_f32_16x16x32_bf16 v[92:95], v[12:15], v[228:231], 0
    v_fma_f32 v120, -v64, s90, v82
    v_fma_f32 v121, -v65, s90, v82
    v_fma_f32 v122, -v66, s90, v82
    v_fma_f32 v123, -v67, s90, v82
    v_fma_f32 v124, -v68, s90, v86
    v_fma_f32 v125, -v69, s90, v86
    v_fma_f32 v126, -v70, s90, v86
    v_fma_f32 v127, -v71, s90, v86
    v_exp_f32 v120, v120
    v_exp_f32 v121, v121
    v_exp_f32 v122, v122
    v_exp_f32 v123, v123
    v_exp_f32 v124, v124
    v_exp_f32 v125, v125
    v_exp_f32 v126, v126
    v_exp_f32 v127, v127
    v_cvt_pk_bf16_f32 v232, v120, v121
    v_cvt_pk_bf16_f32 v233, v122, v123
    v_cvt_pk_bf16_f32 v234, v124, v125
    v_cvt_pk_bf16_f32 v235, v126, v127
    s_nop 1
    v_mfma_f32_16x16x32_bf16 v[96:99], v[12:15], v[232:235], 0
    v_fma_f32 v128, -v72, s90, v83
    v_fma_f32 v129, -v73, s90, v83
    v_fma_f32 v130, -v74, s90, v83
    v_fma_f32 v131, -v75, s90, v83
    v_fma_f32 v132, -v76, s90, v87
    v_fma_f32 v133, -v77, s90, v87
    v_fma_f32 v134, -v78, s90, v87
    v_fma_f32 v135, -v79, s90, v87
    v_exp_f32 v128, v128
    v_exp_f32 v129, v129
    v_exp_f32 v130, v130
    v_exp_f32 v131, v131
    v_exp_f32 v132, v132
    v_exp_f32 v133, v133
    v_exp_f32 v134, v134
    v_exp_f32 v135, v135
    v_cvt_pk_bf16_f32 v236, v128, v129
    v_cvt_pk_bf16_f32 v237, v130, v131
    v_cvt_pk_bf16_f32 v238, v132, v133
    v_cvt_pk_bf16_f32 v239, v134, v135
    s_nop 1
    v_mfma_f32_16x16x32_bf16 v[100:103], v[12:15], v[236:239], 0
    v_rcp_f32 v88, v88
    v_rcp_f32 v92, v92
    v_rcp_f32 v96, v96
    s_nop 4
    v_rcp_f32 v100, v100
    v_pk_mul_f32 v[104:105], v[104:105], v[88:89] op_sel_hi:[1,0]
    v_pk_mul_f32 v[106:107], v[106:107], v[88:89] op_sel_hi:[1,0]
    v_pk_mul_f32 v[108:109], v[108:109], v[88:89] op_sel_hi:[1,0]
    v_pk_mul_f32 v[110:111], v[110:111], v[88:89] op_sel_hi:[1,0]
    v_cvt_pk_bf16_f32 v224, v104, v105
    v_cvt_pk_bf16_f32 v225, v106, v107
    v_cvt_pk_bf16_f32 v226, v108, v109
    v_cvt_pk_bf16_f32 v227, v110, v111
    ds_write_b64 v16, v[224:225] offset:0
    ds_write_b64 v17, v[226:227] offset:0
    v_pk_mul_f32 v[112:113], v[112:113], v[92:93] op_sel_hi:[1,0]
    v_pk_mul_f32 v[114:115], v[114:115], v[92:93] op_sel_hi:[1,0]
    v_pk_mul_f32 v[116:117], v[116:117], v[92:93] op_sel_hi:[1,0]
    v_pk_mul_f32 v[118:119], v[118:119], v[92:93] op_sel_hi:[1,0]
    v_cvt_pk_bf16_f32 v228, v112, v113
    v_cvt_pk_bf16_f32 v229, v114, v115
    v_cvt_pk_bf16_f32 v230, v116, v117
    v_cvt_pk_bf16_f32 v231, v118, v119
    ds_write_b64 v16, v[228:229] offset:2048
    ds_write_b64 v17, v[230:231] offset:2048
    v_pk_mul_f32 v[120:121], v[120:121], v[96:97] op_sel_hi:[1,0]
    v_pk_mul_f32 v[122:123], v[122:123], v[96:97] op_sel_hi:[1,0]
    v_pk_mul_f32 v[124:125], v[124:125], v[96:97] op_sel_hi:[1,0]
    v_pk_mul_f32 v[126:127], v[126:127], v[96:97] op_sel_hi:[1,0]
    v_cvt_pk_bf16_f32 v232, v120, v121
    v_cvt_pk_bf16_f32 v233, v122, v123
    v_cvt_pk_bf16_f32 v234, v124, v125
    v_cvt_pk_bf16_f32 v235, v126, v127
    ds_write_b64 v18, v[232:233] offset:0
    ds_write_b64 v19, v[234:235] offset:0
    v_pk_mul_f32 v[128:129], v[128:129], v[100:101] op_sel_hi:[1,0]
    v_pk_mul_f32 v[130:131], v[130:131], v[100:101] op_sel_hi:[1,0]
    v_pk_mul_f32 v[132:133], v[132:133], v[100:101] op_sel_hi:[1,0]
    v_pk_mul_f32 v[134:135], v[134:135], v[100:101] op_sel_hi:[1,0]
    v_cvt_pk_bf16_f32 v236, v128, v129
    v_cvt_pk_bf16_f32 v237, v130, v131
    v_cvt_pk_bf16_f32 v238, v132, v133
    v_cvt_pk_bf16_f32 v239, v134, v135
    ds_write_b64 v18, v[236:237] offset:2048
    ds_write_b64 v19, v[238:239] offset:2048
    s_waitcnt lgkmcnt(0)
    s_barrier
    ds_read_b64_tr_b16 v[136:137], v20 offset:0
    ds_read_b64_tr_b16 v[138:139], v20 offset:2048
    ds_read_b128 v[152:155], v21 offset:0
    ds_read_b128 v[156:159], v21 offset:1024
    ds_read_b64_tr_b16 v[140:141], v20 offset:4096
    ds_read_b64_tr_b16 v[142:143], v20 offset:6144
    ds_read_b128 v[160:163], v21 offset:2048
    ds_read_b128 v[164:167], v21 offset:3072
    ds_read_b64_tr_b16 v[144:145], v20 offset:8192
    ds_read_b64_tr_b16 v[146:147], v20 offset:10240
    ds_read_b128 v[168:171], v21 offset:4096
    ds_read_b128 v[172:175], v21 offset:5120
    ds_read_b64_tr_b16 v[148:149], v20 offset:12288
    ds_read_b64_tr_b16 v[150:151], v20 offset:14336
    ds_read_b128 v[176:179], v21 offset:6144
    ds_read_b128 v[180:183], v21 offset:7168
    s_waitcnt lgkmcnt(12)
    v_mfma_f32_16x16x32_bf16 v[184:187], v[136:139], v[152:155], 0
    v_mfma_f32_16x16x32_bf16 v[188:191], v[136:139], v[156:159], 0
    s_waitcnt lgkmcnt(8)
    v_mfma_f32_16x16x32_bf16 v[184:187], v[140:143], v[160:163], v[184:187]
    v_mfma_f32_16x16x32_bf16 v[188:191], v[140:143], v[164:167], v[188:191]
    s_waitcnt lgkmcnt(4)
    v_mfma_f32_16x16x32_bf16 v[184:187], v[144:147], v[168:171], v[184:187]
    v_mfma_f32_16x16x32_bf16 v[188:191], v[144:147], v[172:175], v[188:191]
    s_waitcnt lgkmcnt(0)
    v_mfma_f32_16x16x32_bf16 v[184:187], v[148:151], v[176:179], v[184:187]
    v_mfma_f32_16x16x32_bf16 v[188:191], v[148:151], v[180:183], v[188:191]
    s_nop 6
    v_cvt_pk_bf16_f32 v192, v184, v185
    v_cvt_pk_bf16_f32 v193, v186, v187
    v_cvt_pk_bf16_f32 v194, v188, v189
    v_cvt_pk_bf16_f32 v195, v190, v191
    v_min_u32 v192, 0xfffffffe, v192
    v_min_u32 v193, 0xfffffffe, v193
    v_min_u32 v194, 0xfffffffe, v194
    v_min_u32 v195, 0xfffffffe, v195
    buffer_store_dwordx4 v[192:195], v11, s[16:19], s36 offen sc1
    v_lshrrev_b32 v3, 2, v1
    v_and_b32 v4, 3, v0
    v_lshl_add_u32 v5, v2, 2, v3
    v_lshlrev_b32 v5, 7, v5
    v_lshl_add_u32 v5, v4, 3, v5
    s_mul_i32 s53, s52, 28672
    s_add_u32 s53, s53, 57344
    v_add_u32 v5, s53, v5
    v_lshrrev_b32 v6, 1, v3
    v_lshl_add_u32 v6, v2, 1, v6
    v_add_u32 v8, 0, v6
    v_and_b32 v8, 3, v8
    v_xor_b32 v9, 0, v8
    v_lshl_add_u32 v16, v9, 5, v5
    v_xor_b32 v9, 1, v8
    v_lshl_add_u32 v17, v9, 5, v5
    v_xor_b32 v9, 2, v8
    v_lshl_add_u32 v18, v9, 5, v5
    v_xor_b32 v9, 3, v8
    v_lshl_add_u32 v19, v9, 5, v5
    v_add_u32 v8, 2, v6
    v_and_b32 v8, 3, v8
    v_xor_b32 v9, 0, v8
    v_lshl_add_u32 v20, v9, 5, v5
    v_xor_b32 v9, 1, v8
    v_lshl_add_u32 v21, v9, 5, v5
    v_xor_b32 v9, 2, v8
    v_lshl_add_u32 v22, v9, 5, v5
    v_xor_b32 v9, 3, v8
    v_lshl_add_u32 v23, v9, 5, v5
    s_and_b32 s54, s35, 3
    s_lshl_b32 s63, s46, 1
    s_xor_b32 s55, s34, 1
    s_add_u32 s63, s63, s55
    s_lshl_b32 s63, s63, 2
    s_add_u32 s63, s63, s54
    s_lshl_b32 s64, s63, 14
    s_lshl_b32 s53, s52, 13
    s_add_u32 s64, s64, s53
    s_lshr_b32 s65, s63, 1
    s_lshl_b32 s65, s65, 8
    s_add_u32 s65, s65, 6307840
    s_lshl_b32 s66, s52, 3
    v_and_b32 v6, 1, v2
    v_lshlrev_b32 v6, 9, v6
    v_lshl_add_u32 v6, v1, 2, v6
    v_lshlrev_b32 v7, 2, v1
    s_waitcnt vmcnt(1)
    s_mov_b32 s3, 0
L_GN_5:
    v_readfirstlane_b32 s49, v254
    s_nop 0
    s_cmp_lg_u32 s49, 0
    s_nop 2
    s_cbranch_scc1 L_GNX_5
    s_sleep 2
    v_mov_b32 v252, 0
    buffer_load_dword v254, v252, s[28:31], 0 offen sc1
    s_waitcnt vmcnt(0)
    s_add_u32 s3, s3, 1
    s_cmp_lt_u32 s3, 200000
    s_cbranch_scc1 L_GN_5
L_GNX_5:
    s_or_b32 s53, s33, s50
    s_or_b32 s53, s53, s52
    s_cmp_lg_u32 s53, 0
    s_cbranch_scc1 L_NOGF
    s_lshl_b32 s53, s32, 8
    s_lshl_b32 s5, s51, 2
    s_add_u32 s53, s53, s5
    s_add_u32 s53, s53, 6340608
    v_mov_b32 v252, 0
    v_mov_b32 v255, s49
    s_mov_b64 exec, 1
    buffer_store_dword v255, v252, s[16:19], s53 offen sc1
    s_mov_b64 exec, -1
L_NOGF:
    s_cmp_lt_u32 s45, 14
    s_cbranch_scc1 L_NORED
    s_cmp_ge_u32 s35, 2
    s_cbranch_scc1 L_END
    v_lshrrev_b32 v4, 2, v1
    v_cmp_eq_u32 vcc, v4, v2
    v_and_b32 v4, 3, v1
    v_and_b32 v5, 1, v4
    v_lshlrev_b32 v5, 4, v5
    v_mov_b32 v8, 0x3f80
    v_lshlrev_b32 v8, v5, v8
    v_cndmask_b32 v8, 0, v8, vcc
    v_cmp_gt_u32 vcc, 2, v4
    s_nop 1
    v_cndmask_b32 v184, 0, v8, vcc
    v_cndmask_b32 v185, v8, 0, vcc
    v_mov_b32 v186, 0
    v_mov_b32 v187, 0
    v_mov_b32 v188, 0
    v_mov_b32 v189, 0
    v_mov_b32 v190, v184
    v_mov_b32 v191, v185
    v_mov_b32 v192, 0
    v_mov_b32 v193, 0
    v_mov_b32 v194, 0
    v_mov_b32 v195, 0
    v_mov_b32 v196, 0
    v_mov_b32 v197, 0
    v_mov_b32 v198, 0
    v_mov_b32 v199, 0
    v_mov_b32 v200, 0
    v_mov_b32 v201, 0
    v_mov_b32 v202, 0
    v_mov_b32 v203, 0
    v_mov_b32 v204, 0
    v_mov_b32 v205, 0
    v_mov_b32 v206, 0
    v_mov_b32 v207, 0
    s_mov_b32 s3, 0
    s_mov_b32 s42, 0
    s_mov_b32 s43, 0
L_GA_6:
    s_andn2_b32 s7, s43, s42
    s_cmp_eq_u32 s7, 65535
    s_cbranch_scc1 L_GF_6
    s_cmp_eq_u32 s43, 65535
    s_cbranch_scc1 L_GNP_6
    buffer_load_dword v253, v6, s[16:19], s38 offen sc1
L_GNP_6:
    s_cmp_eq_u32 s7, 0
    s_cbranch_scc1 L_GNL_6
    s_bitcmp1_b32 s7, 0
    s_cbranch_scc0 L_GK_6_0
    s_add_u32 s53, s39, 0
    buffer_load_dwordx4 v[56:59], v11, s[16:19], s53 offen sc1
    buffer_load_dwordx4 v[60:63], v11, s[16:19], s53 offen offset:2048 sc1
L_GK_6_0:
    s_bitcmp1_b32 s7, 1
    s_cbranch_scc0 L_GK_6_1
    s_add_u32 s53, s39, 8192
    buffer_load_dwordx4 v[64:67], v11, s[16:19], s53 offen sc1
    buffer_load_dwordx4 v[68:71], v11, s[16:19], s53 offen offset:2048 sc1
L_GK_6_1:
    s_bitcmp1_b32 s7, 2
    s_cbranch_scc0 L_GK_6_2
    s_add_u32 s53, s39, 16384
    buffer_load_dwordx4 v[72:75], v11, s[16:19], s53 offen sc1
    buffer_load_dwordx4 v[76:79], v11, s[16:19], s53 offen offset:2048 sc1
L_GK_6_2:
    s_bitcmp1_b32 s7, 3
    s_cbranch_scc0 L_GK_6_3
    s_add_u32 s53, s39, 24576
    buffer_load_dwordx4 v[80:83], v11, s[16:19], s53 offen sc1
    buffer_load_dwordx4 v[84:87], v11, s[16:19], s53 offen offset:2048 sc1
L_GK_6_3:
    s_bitcmp1_b32 s7, 4
    s_cbranch_scc0 L_GK_6_4
    s_add_u32 s53, s39, 32768
    buffer_load_dwordx4 v[88:91], v11, s[16:19], s53 offen sc1
    buffer_load_dwordx4 v[92:95], v11, s[16:19], s53 offen offset:2048 sc1
L_GK_6_4:
    s_bitcmp1_b32 s7, 5
    s_cbranch_scc0 L_GK_6_5
    s_add_u32 s53, s39, 40960
    buffer_load_dwordx4 v[96:99], v11, s[16:19], s53 offen sc1
    buffer_load_dwordx4 v[100:103], v11, s[16:19], s53 offen offset:2048 sc1
L_GK_6_5:
    s_bitcmp1_b32 s7, 6
    s_cbranch_scc0 L_GK_6_6
    s_add_u32 s53, s39, 49152
    buffer_load_dwordx4 v[104:107], v11, s[16:19], s53 offen sc1
    buffer_load_dwordx4 v[108:111], v11, s[16:19], s53 offen offset:2048 sc1
L_GK_6_6:
    s_bitcmp1_b32 s7, 7
    s_cbranch_scc0 L_GK_6_7
    s_add_u32 s53, s39, 57344
    buffer_load_dwordx4 v[112:115], v11, s[16:19], s53 offen sc1
    buffer_load_dwordx4 v[116:119], v11, s[16:19], s53 offen offset:2048 sc1
L_GK_6_7:
    s_bitcmp1_b32 s7, 8
    s_cbranch_scc0 L_GK_6_8
    s_add_u32 s53, s39, 65536
    buffer_load_dwordx4 v[120:123], v11, s[16:19], s53 offen sc1
    buffer_load_dwordx4 v[124:127], v11, s[16:19], s53 offen offset:2048 sc1
L_GK_6_8:
    s_bitcmp1_b32 s7, 9
    s_cbranch_scc0 L_GK_6_9
    s_add_u32 s53, s39, 73728
    buffer_load_dwordx4 v[128:131], v11, s[16:19], s53 offen sc1
    buffer_load_dwordx4 v[132:135], v11, s[16:19], s53 offen offset:2048 sc1
L_GK_6_9:
    s_bitcmp1_b32 s7, 10
    s_cbranch_scc0 L_GK_6_10
    s_add_u32 s53, s39, 81920
    buffer_load_dwordx4 v[136:139], v11, s[16:19], s53 offen sc1
    buffer_load_dwordx4 v[140:143], v11, s[16:19], s53 offen offset:2048 sc1
L_GK_6_10:
    s_bitcmp1_b32 s7, 11
    s_cbranch_scc0 L_GK_6_11
    s_add_u32 s53, s39, 90112
    buffer_load_dwordx4 v[144:147], v11, s[16:19], s53 offen sc1
    buffer_load_dwordx4 v[148:151], v11, s[16:19], s53 offen offset:2048 sc1
L_GK_6_11:
    s_bitcmp1_b32 s7, 12
    s_cbranch_scc0 L_GK_6_12
    s_add_u32 s53, s39, 98304
    buffer_load_dwordx4 v[152:155], v11, s[16:19], s53 offen sc1
    buffer_load_dwordx4 v[156:159], v11, s[16:19], s53 offen offset:2048 sc1
L_GK_6_12:
    s_bitcmp1_b32 s7, 13
    s_cbranch_scc0 L_GK_6_13
    s_add_u32 s53, s39, 106496
    buffer_load_dwordx4 v[160:163], v11, s[16:19], s53 offen sc1
    buffer_load_dwordx4 v[164:167], v11, s[16:19], s53 offen offset:2048 sc1
L_GK_6_13:
    s_bitcmp1_b32 s7, 14
    s_cbranch_scc0 L_GK_6_14
    s_add_u32 s53, s39, 114688
    buffer_load_dwordx4 v[168:171], v11, s[16:19], s53 offen sc1
    buffer_load_dwordx4 v[172:175], v11, s[16:19], s53 offen offset:2048 sc1
L_GK_6_14:
    s_bitcmp1_b32 s7, 15
    s_cbranch_scc0 L_GK_6_15
    s_add_u32 s53, s39, 122880
    buffer_load_dwordx4 v[176:179], v11, s[16:19], s53 offen sc1
    buffer_load_dwordx4 v[180:183], v11, s[16:19], s53 offen offset:2048 sc1
L_GK_6_15:
L_GNL_6:
    s_waitcnt vmcnt(0)
    v_cmp_eq_u32 vcc, s49, v253
    s_nop 0
    s_lshr_b32 s4, vcc_lo, 16
    s_and_b32 s4, s4, vcc_lo
    s_or_b32 s43, s43, s4
    s_cmp_eq_u32 s7, 0
    s_cbranch_scc1 L_GNC_6
    s_bitcmp1_b32 s7, 0
    s_cbranch_scc0 L_GCL_6_0
    v_max3_u32 v255, v56, v57, v58
    v_max3_u32 v255, v255, v59, v60
    v_max3_u32 v255, v255, v61, v62
    v_max_u32 v255, v255, v63
    v_cmp_eq_u32 vcc, -1, v255
    s_nop 0
    s_cmp_lg_u64 vcc, 0
    s_cbranch_scc1 L_GCL_6_0
    v_mfma_f32_16x16x32_bf16 v[192:195], v[184:187], v[56:59], v[192:195]
    v_mfma_f32_16x16x32_bf16 v[200:203], v[188:191], v[56:59], v[200:203]
    v_mfma_f32_16x16x32_bf16 v[196:199], v[184:187], v[60:63], v[196:199]
    v_mfma_f32_16x16x32_bf16 v[204:207], v[188:191], v[60:63], v[204:207]
    s_bitset1_b32 s42, 0
L_GCL_6_0:
    s_bitcmp1_b32 s7, 1
    s_cbranch_scc0 L_GCL_6_1
    v_max3_u32 v255, v64, v65, v66
    v_max3_u32 v255, v255, v67, v68
    v_max3_u32 v255, v255, v69, v70
    v_max_u32 v255, v255, v71
    v_cmp_eq_u32 vcc, -1, v255
    s_nop 0
    s_cmp_lg_u64 vcc, 0
    s_cbranch_scc1 L_GCL_6_1
    v_mfma_f32_16x16x32_bf16 v[192:195], v[184:187], v[64:67], v[192:195]
    v_mfma_f32_16x16x32_bf16 v[200:203], v[188:191], v[64:67], v[200:203]
    v_mfma_f32_16x16x32_bf16 v[196:199], v[184:187], v[68:71], v[196:199]
    v_mfma_f32_16x16x32_bf16 v[204:207], v[188:191], v[68:71], v[204:207]
    s_bitset1_b32 s42, 1
L_GCL_6_1:
    s_bitcmp1_b32 s7, 2
    s_cbranch_scc0 L_GCL_6_2
    v_max3_u32 v255, v72, v73, v74
    v_max3_u32 v255, v255, v75, v76
    v_max3_u32 v255, v255, v77, v78
    v_max_u32 v255, v255, v79
    v_cmp_eq_u32 vcc, -1, v255
    s_nop 0
    s_cmp_lg_u64 vcc, 0
    s_cbranch_scc1 L_GCL_6_2
    v_mfma_f32_16x16x32_bf16 v[192:195], v[184:187], v[72:75], v[192:195]
    v_mfma_f32_16x16x32_bf16 v[200:203], v[188:191], v[72:75], v[200:203]
    v_mfma_f32_16x16x32_bf16 v[196:199], v[184:187], v[76:79], v[196:199]
    v_mfma_f32_16x16x32_bf16 v[204:207], v[188:191], v[76:79], v[204:207]
    s_bitset1_b32 s42, 2
L_GCL_6_2:
    s_bitcmp1_b32 s7, 3
    s_cbranch_scc0 L_GCL_6_3
    v_max3_u32 v255, v80, v81, v82
    v_max3_u32 v255, v255, v83, v84
    v_max3_u32 v255, v255, v85, v86
    v_max_u32 v255, v255, v87
    v_cmp_eq_u32 vcc, -1, v255
    s_nop 0
    s_cmp_lg_u64 vcc, 0
    s_cbranch_scc1 L_GCL_6_3
    v_mfma_f32_16x16x32_bf16 v[192:195], v[184:187], v[80:83], v[192:195]
    v_mfma_f32_16x16x32_bf16 v[200:203], v[188:191], v[80:83], v[200:203]
    v_mfma_f32_16x16x32_bf16 v[196:199], v[184:187], v[84:87], v[196:199]
    v_mfma_f32_16x16x32_bf16 v[204:207], v[188:191], v[84:87], v[204:207]
    s_bitset1_b32 s42, 3
L_GCL_6_3:
    s_bitcmp1_b32 s7, 4
    s_cbranch_scc0 L_GCL_6_4
    v_max3_u32 v255, v88, v89, v90
    v_max3_u32 v255, v255, v91, v92
    v_max3_u32 v255, v255, v93, v94
    v_max_u32 v255, v255, v95
    v_cmp_eq_u32 vcc, -1, v255
    s_nop 0
    s_cmp_lg_u64 vcc, 0
    s_cbranch_scc1 L_GCL_6_4
    v_mfma_f32_16x16x32_bf16 v[192:195], v[184:187], v[88:91], v[192:195]
    v_mfma_f32_16x16x32_bf16 v[200:203], v[188:191], v[88:91], v[200:203]
    v_mfma_f32_16x16x32_bf16 v[196:199], v[184:187], v[92:95], v[196:199]
    v_mfma_f32_16x16x32_bf16 v[204:207], v[188:191], v[92:95], v[204:207]
    s_bitset1_b32 s42, 4
L_GCL_6_4:
    s_bitcmp1_b32 s7, 5
    s_cbranch_scc0 L_GCL_6_5
    v_max3_u32 v255, v96, v97, v98
    v_max3_u32 v255, v255, v99, v100
    v_max3_u32 v255, v255, v101, v102
    v_max_u32 v255, v255, v103
    v_cmp_eq_u32 vcc, -1, v255
    s_nop 0
    s_cmp_lg_u64 vcc, 0
    s_cbranch_scc1 L_GCL_6_5
    v_mfma_f32_16x16x32_bf16 v[192:195], v[184:187], v[96:99], v[192:195]
    v_mfma_f32_16x16x32_bf16 v[200:203], v[188:191], v[96:99], v[200:203]
    v_mfma_f32_16x16x32_bf16 v[196:199], v[184:187], v[100:103], v[196:199]
    v_mfma_f32_16x16x32_bf16 v[204:207], v[188:191], v[100:103], v[204:207]
    s_bitset1_b32 s42, 5
L_GCL_6_5:
    s_bitcmp1_b32 s7, 6
    s_cbranch_scc0 L_GCL_6_6
    v_max3_u32 v255, v104, v105, v106
    v_max3_u32 v255, v255, v107, v108
    v_max3_u32 v255, v255, v109, v110
    v_max_u32 v255, v255, v111
    v_cmp_eq_u32 vcc, -1, v255
    s_nop 0
    s_cmp_lg_u64 vcc, 0
    s_cbranch_scc1 L_GCL_6_6
    v_mfma_f32_16x16x32_bf16 v[192:195], v[184:187], v[104:107], v[192:195]
    v_mfma_f32_16x16x32_bf16 v[200:203], v[188:191], v[104:107], v[200:203]
    v_mfma_f32_16x16x32_bf16 v[196:199], v[184:187], v[108:111], v[196:199]
    v_mfma_f32_16x16x32_bf16 v[204:207], v[188:191], v[108:111], v[204:207]
    s_bitset1_b32 s42, 6
L_GCL_6_6:
    s_bitcmp1_b32 s7, 7
    s_cbranch_scc0 L_GCL_6_7
    v_max3_u32 v255, v112, v113, v114
    v_max3_u32 v255, v255, v115, v116
    v_max3_u32 v255, v255, v117, v118
    v_max_u32 v255, v255, v119
    v_cmp_eq_u32 vcc, -1, v255
    s_nop 0
    s_cmp_lg_u64 vcc, 0
    s_cbranch_scc1 L_GCL_6_7
    v_mfma_f32_16x16x32_bf16 v[192:195], v[184:187], v[112:115], v[192:195]
    v_mfma_f32_16x16x32_bf16 v[200:203], v[188:191], v[112:115], v[200:203]
    v_mfma_f32_16x16x32_bf16 v[196:199], v[184:187], v[116:119], v[196:199]
    v_mfma_f32_16x16x32_bf16 v[204:207], v[188:191], v[116:119], v[204:207]
    s_bitset1_b32 s42, 7
L_GCL_6_7:
    s_bitcmp1_b32 s7, 8
    s_cbranch_scc0 L_GCL_6_8
    v_max3_u32 v255, v120, v121, v122
    v_max3_u32 v255, v255, v123, v124
    v_max3_u32 v255, v255, v125, v126
    v_max_u32 v255, v255, v127
    v_cmp_eq_u32 vcc, -1, v255
    s_nop 0
    s_cmp_lg_u64 vcc, 0
    s_cbranch_scc1 L_GCL_6_8
    v_mfma_f32_16x16x32_bf16 v[192:195], v[184:187], v[120:123], v[192:195]
    v_mfma_f32_16x16x32_bf16 v[200:203], v[188:191], v[120:123], v[200:203]
    v_mfma_f32_16x16x32_bf16 v[196:199], v[184:187], v[124:127], v[196:199]
    v_mfma_f32_16x16x32_bf16 v[204:207], v[188:191], v[124:127], v[204:207]
    s_bitset1_b32 s42, 8
L_GCL_6_8:
    s_bitcmp1_b32 s7, 9
    s_cbranch_scc0 L_GCL_6_9
    v_max3_u32 v255, v128, v129, v130
    v_max3_u32 v255, v255, v131, v132
    v_max3_u32 v255, v255, v133, v134
    v_max_u32 v255, v255, v135
    v_cmp_eq_u32 vcc, -1, v255
    s_nop 0
    s_cmp_lg_u64 vcc, 0
    s_cbranch_scc1 L_GCL_6_9
    v_mfma_f32_16x16x32_bf16 v[192:195], v[184:187], v[128:131], v[192:195]
    v_mfma_f32_16x16x32_bf16 v[200:203], v[188:191], v[128:131], v[200:203]
    v_mfma_f32_16x16x32_bf16 v[196:199], v[184:187], v[132:135], v[196:199]
    v_mfma_f32_16x16x32_bf16 v[204:207], v[188:191], v[132:135], v[204:207]
    s_bitset1_b32 s42, 9
L_GCL_6_9:
    s_bitcmp1_b32 s7, 10
    s_cbranch_scc0 L_GCL_6_10
    v_max3_u32 v255, v136, v137, v138
    v_max3_u32 v255, v255, v139, v140
    v_max3_u32 v255, v255, v141, v142
    v_max_u32 v255, v255, v143
    v_cmp_eq_u32 vcc, -1, v255
    s_nop 0
    s_cmp_lg_u64 vcc, 0
    s_cbranch_scc1 L_GCL_6_10
    v_mfma_f32_16x16x32_bf16 v[192:195], v[184:187], v[136:139], v[192:195]
    v_mfma_f32_16x16x32_bf16 v[200:203], v[188:191], v[136:139], v[200:203]
    v_mfma_f32_16x16x32_bf16 v[196:199], v[184:187], v[140:143], v[196:199]
    v_mfma_f32_16x16x32_bf16 v[204:207], v[188:191], v[140:143], v[204:207]
    s_bitset1_b32 s42, 10
L_GCL_6_10:
    s_bitcmp1_b32 s7, 11
    s_cbranch_scc0 L_GCL_6_11
    v_max3_u32 v255, v144, v145, v146
    v_max3_u32 v255, v255, v147, v148
    v_max3_u32 v255, v255, v149, v150
    v_max_u32 v255, v255, v151
    v_cmp_eq_u32 vcc, -1, v255
    s_nop 0
    s_cmp_lg_u64 vcc, 0
    s_cbranch_scc1 L_GCL_6_11
    v_mfma_f32_16x16x32_bf16 v[192:195], v[184:187], v[144:147], v[192:195]
    v_mfma_f32_16x16x32_bf16 v[200:203], v[188:191], v[144:147], v[200:203]
    v_mfma_f32_16x16x32_bf16 v[196:199], v[184:187], v[148:151], v[196:199]
    v_mfma_f32_16x16x32_bf16 v[204:207], v[188:191], v[148:151], v[204:207]
    s_bitset1_b32 s42, 11
L_GCL_6_11:
    s_bitcmp1_b32 s7, 12
    s_cbranch_scc0 L_GCL_6_12
    v_max3_u32 v255, v152, v153, v154
    v_max3_u32 v255, v255, v155, v156
    v_max3_u32 v255, v255, v157, v158
    v_max_u32 v255, v255, v159
    v_cmp_eq_u32 vcc, -1, v255
    s_nop 0
    s_cmp_lg_u64 vcc, 0
    s_cbranch_scc1 L_GCL_6_12
    v_mfma_f32_16x16x32_bf16 v[192:195], v[184:187], v[152:155], v[192:195]
    v_mfma_f32_16x16x32_bf16 v[200:203], v[188:191], v[152:155], v[200:203]
    v_mfma_f32_16x16x32_bf16 v[196:199], v[184:187], v[156:159], v[196:199]
    v_mfma_f32_16x16x32_bf16 v[204:207], v[188:191], v[156:159], v[204:207]
    s_bitset1_b32 s42, 12
L_GCL_6_12:
    s_bitcmp1_b32 s7, 13
    s_cbranch_scc0 L_GCL_6_13
    v_max3_u32 v255, v160, v161, v162
    v_max3_u32 v255, v255, v163, v164
    v_max3_u32 v255, v255, v165, v166
    v_max_u32 v255, v255, v167
    v_cmp_eq_u32 vcc, -1, v255
    s_nop 0
    s_cmp_lg_u64 vcc, 0
    s_cbranch_scc1 L_GCL_6_13
    v_mfma_f32_16x16x32_bf16 v[192:195], v[184:187], v[160:163], v[192:195]
    v_mfma_f32_16x16x32_bf16 v[200:203], v[188:191], v[160:163], v[200:203]
    v_mfma_f32_16x16x32_bf16 v[196:199], v[184:187], v[164:167], v[196:199]
    v_mfma_f32_16x16x32_bf16 v[204:207], v[188:191], v[164:167], v[204:207]
    s_bitset1_b32 s42, 13
L_GCL_6_13:
    s_bitcmp1_b32 s7, 14
    s_cbranch_scc0 L_GCL_6_14
    v_max3_u32 v255, v168, v169, v170
    v_max3_u32 v255, v255, v171, v172
    v_max3_u32 v255, v255, v173, v174
    v_max_u32 v255, v255, v175
    v_cmp_eq_u32 vcc, -1, v255
    s_nop 0
    s_cmp_lg_u64 vcc, 0
    s_cbranch_scc1 L_GCL_6_14
    v_mfma_f32_16x16x32_bf16 v[192:195], v[184:187], v[168:171], v[192:195]
    v_mfma_f32_16x16x32_bf16 v[200:203], v[188:191], v[168:171], v[200:203]
    v_mfma_f32_16x16x32_bf16 v[196:199], v[184:187], v[172:175], v[196:199]
    v_mfma_f32_16x16x32_bf16 v[204:207], v[188:191], v[172:175], v[204:207]
    s_bitset1_b32 s42, 14
L_GCL_6_14:
    s_bitcmp1_b32 s7, 15
    s_cbranch_scc0 L_GCL_6_15
    v_max3_u32 v255, v176, v177, v178
    v_max3_u32 v255, v255, v179, v180
    v_max3_u32 v255, v255, v181, v182
    v_max_u32 v255, v255, v183
    v_cmp_eq_u32 vcc, -1, v255
    s_nop 0
    s_cmp_lg_u64 vcc, 0
    s_cbranch_scc1 L_GCL_6_15
    v_mfma_f32_16x16x32_bf16 v[192:195], v[184:187], v[176:179], v[192:195]
    v_mfma_f32_16x16x32_bf16 v[200:203], v[188:191], v[176:179], v[200:203]
    v_mfma_f32_16x16x32_bf16 v[196:199], v[184:187], v[180:183], v[196:199]
    v_mfma_f32_16x16x32_bf16 v[204:207], v[188:191], v[180:183], v[204:207]
    s_bitset1_b32 s42, 15
L_GCL_6_15:
L_GNC_6:
    s_cmp_eq_u32 s42, 65535
    s_cbranch_scc1 L_GAX_6
    s_add_u32 s3, s3, 1
    s_cmp_lt_u32 s3, 200000
    s_cbranch_scc1 L_GA_6
    s_branch L_GAX_6
L_GF_6:
    s_add_u32 s53, s39, 0
    buffer_load_dwordx4 v[56:59], v11, s[16:19], s53 offen sc1
    buffer_load_dwordx4 v[60:63], v11, s[16:19], s53 offen offset:2048 sc1
    s_add_u32 s53, s39, 8192
    buffer_load_dwordx4 v[64:67], v11, s[16:19], s53 offen sc1
    buffer_load_dwordx4 v[68:71], v11, s[16:19], s53 offen offset:2048 sc1
    s_add_u32 s53, s39, 16384
    buffer_load_dwordx4 v[72:75], v11, s[16:19], s53 offen sc1
    buffer_load_dwordx4 v[76:79], v11, s[16:19], s53 offen offset:2048 sc1
    s_add_u32 s53, s39, 24576
    buffer_load_dwordx4 v[80:83], v11, s[16:19], s53 offen sc1
    buffer_load_dwordx4 v[84:87], v11, s[16:19], s53 offen offset:2048 sc1
    s_add_u32 s53, s39, 32768
    buffer_load_dwordx4 v[88:91], v11, s[16:19], s53 offen sc1
    buffer_load_dwordx4 v[92:95], v11, s[16:19], s53 offen offset:2048 sc1
    s_add_u32 s53, s39, 40960
    buffer_load_dwordx4 v[96:99], v11, s[16:19], s53 offen sc1
    buffer_load_dwordx4 v[100:103], v11, s[16:19], s53 offen offset:2048 sc1
    s_add_u32 s53, s39, 49152
    buffer_load_dwordx4 v[104:107], v11, s[16:19], s53 offen sc1
    buffer_load_dwordx4 v[108:111], v11, s[16:19], s53 offen offset:2048 sc1
    s_waitcnt vmcnt(12)
    v_max3_u32 v255, v56, v57, v58
    v_max3_u32 v255, v255, v59, v60
    v_max3_u32 v255, v255, v61, v62
    v_max_u32 v255, v255, v63
    v_cmp_eq_u32 vcc, -1, v255
    s_nop 0
    s_cmp_lg_u64 vcc, 0
    s_cbranch_scc1 L_GCF_6_0
    v_mfma_f32_16x16x32_bf16 v[192:195], v[184:187], v[56:59], v[192:195]
    v_mfma_f32_16x16x32_bf16 v[200:203], v[188:191], v[56:59], v[200:203]
    v_mfma_f32_16x16x32_bf16 v[196:199], v[184:187], v[60:63], v[196:199]
    v_mfma_f32_16x16x32_bf16 v[204:207], v[188:191], v[60:63], v[204:207]
    s_bitset1_b32 s42, 0
L_GCF_6_0:
    s_add_u32 s53, s39, 57344
    buffer_load_dwordx4 v[112:115], v11, s[16:19], s53 offen sc1
    buffer_load_dwordx4 v[116:119], v11, s[16:19], s53 offen offset:2048 sc1
    s_waitcnt vmcnt(12)
    v_max3_u32 v255, v64, v65, v66
    v_max3_u32 v255, v255, v67, v68
    v_max3_u32 v255, v255, v69, v70
    v_max_u32 v255, v255, v71
    v_cmp_eq_u32 vcc, -1, v255
    s_nop 0
    s_cmp_lg_u64 vcc, 0
    s_cbranch_scc1 L_GCF_6_1
    v_mfma_f32_16x16x32_bf16 v[192:195], v[184:187], v[64:67], v[192:195]
    v_mfma_f32_16x16x32_bf16 v[200:203], v[188:191], v[64:67], v[200:203]
    v_mfma_f32_16x16x32_bf16 v[196:199], v[184:187], v[68:71], v[196:199]
    v_mfma_f32_16x16x32_bf16 v[204:207], v[188:191], v[68:71], v[204:207]
    s_bitset1_b32 s42, 1
L_GCF_6_1:
    s_add_u32 s53, s39, 65536
    buffer_load_dwordx4 v[120:123], v11, s[16:19], s53 offen sc1
    buffer_load_dwordx4 v[124:127], v11, s[16:19], s53 offen offset:2048 sc1
    s_waitcnt vmcnt(12)
    v_max3_u32 v255, v72, v73, v74
    v_max3_u32 v255, v255, v75, v76
    v_max3_u32 v255, v255, v77, v78
    v_max_u32 v255, v255, v79
    v_cmp_eq_u32 vcc, -1, v255
    s_nop 0
    s_cmp_lg_u64 vcc, 0
    s_cbranch_scc1 L_GCF_6_2
    v_mfma_f32_16x16x32_bf16 v[192:195], v[184:187], v[72:75], v[192:195]
    v_mfma_f32_16x16x32_bf16 v[200:203], v[188:191], v[72:75], v[200:203]
    v_mfma_f32_16x16x32_bf16 v[196:199], v[184:187], v[76:79], v[196:199]
    v_mfma_f32_16x16x32_bf16 v[204:207], v[188:191], v[76:79], v[204:207]
    s_bitset1_b32 s42, 2
L_GCF_6_2:
    s_add_u32 s53, s39, 73728
    buffer_load_dwordx4 v[128:131], v11, s[16:19], s53 offen sc1
    buffer_load_dwordx4 v[132:135], v11, s[16:19], s53 offen offset:2048 sc1
    s_waitcnt vmcnt(12)
    v_max3_u32 v255, v80, v81, v82
    v_max3_u32 v255, v255, v83, v84
    v_max3_u32 v255, v255, v85, v86
    v_max_u32 v255, v255, v87
    v_cmp_eq_u32 vcc, -1, v255
    s_nop 0
    s_cmp_lg_u64 vcc, 0
    s_cbranch_scc1 L_GCF_6_3
    v_mfma_f32_16x16x32_bf16 v[192:195], v[184:187], v[80:83], v[192:195]
    v_mfma_f32_16x16x32_bf16 v[200:203], v[188:191], v[80:83], v[200:203]
    v_mfma_f32_16x16x32_bf16 v[196:199], v[184:187], v[84:87], v[196:199]
    v_mfma_f32_16x16x32_bf16 v[204:207], v[188:191], v[84:87], v[204:207]
    s_bitset1_b32 s42, 3
L_GCF_6_3:
    s_add_u32 s53, s39, 81920
    buffer_load_dwordx4 v[136:139], v11, s[16:19], s53 offen sc1
    buffer_load_dwordx4 v[140:143], v11, s[16:19], s53 offen offset:2048 sc1
    s_waitcnt vmcnt(12)
    v_max3_u32 v255, v88, v89, v90
    v_max3_u32 v255, v255, v91, v92
    v_max3_u32 v255, v255, v93, v94
    v_max_u32 v255, v255, v95
    v_cmp_eq_u32 vcc, -1, v255
    s_nop 0
    s_cmp_lg_u64 vcc, 0
    s_cbranch_scc1 L_GCF_6_4
    v_mfma_f32_16x16x32_bf16 v[192:195], v[184:187], v[88:91], v[192:195]
    v_mfma_f32_16x16x32_bf16 v[200:203], v[188:191], v[88:91], v[200:203]
    v_mfma_f32_16x16x32_bf16 v[196:199], v[184:187], v[92:95], v[196:199]
    v_mfma_f32_16x16x32_bf16 v[204:207], v[188:191], v[92:95], v[204:207]
    s_bitset1_b32 s42, 4
L_GCF_6_4:
    s_add_u32 s53, s39, 90112
    buffer_load_dwordx4 v[144:147], v11, s[16:19], s53 offen sc1
    buffer_load_dwordx4 v[148:151], v11, s[16:19], s53 offen offset:2048 sc1
    s_waitcnt vmcnt(12)
    v_max3_u32 v255, v96, v97, v98
    v_max3_u32 v255, v255, v99, v100
    v_max3_u32 v255, v255, v101, v102
    v_max_u32 v255, v255, v103
    v_cmp_eq_u32 vcc, -1, v255
    s_nop 0
    s_cmp_lg_u64 vcc, 0
    s_cbranch_scc1 L_GCF_6_5
    v_mfma_f32_16x16x32_bf16 v[192:195], v[184:187], v[96:99], v[192:195]
    v_mfma_f32_16x16x32_bf16 v[200:203], v[188:191], v[96:99], v[200:203]
    v_mfma_f32_16x16x32_bf16 v[196:199], v[184:187], v[100:103], v[196:199]
    v_mfma_f32_16x16x32_bf16 v[204:207], v[188:191], v[100:103], v[204:207]
    s_bitset1_b32 s42, 5
L_GCF_6_5:
    s_add_u32 s53, s39, 98304
    buffer_load_dwordx4 v[152:155], v11, s[16:19], s53 offen sc1
    buffer_load_dwordx4 v[156:159], v11, s[16:19], s53 offen offset:2048 sc1
    s_waitcnt vmcnt(12)
    v_max3_u32 v255, v104, v105, v106
    v_max3_u32 v255, v255, v107, v108
    v_max3_u32 v255, v255, v109, v110
    v_max_u32 v255, v255, v111
    v_cmp_eq_u32 vcc, -1, v255
    s_nop 0
    s_cmp_lg_u64 vcc, 0
    s_cbranch_scc1 L_GCF_6_6
    v_mfma_f32_16x16x32_bf16 v[192:195], v[184:187], v[104:107], v[192:195]
    v_mfma_f32_16x16x32_bf16 v[200:203], v[188:191], v[104:107], v[200:203]
    v_mfma_f32_16x16x32_bf16 v[196:199], v[184:187], v[108:111], v[196:199]
    v_mfma_f32_16x16x32_bf16 v[204:207], v[188:191], v[108:111], v[204:207]
    s_bitset1_b32 s42, 6
L_GCF_6_6:
    s_add_u32 s53, s39, 106496
    buffer_load_dwordx4 v[160:163], v11, s[16:19], s53 offen sc1
    buffer_load_dwordx4 v[164:167], v11, s[16:19], s53 offen offset:2048 sc1
    s_waitcnt vmcnt(12)
    v_max3_u32 v255, v112, v113, v114
    v_max3_u32 v255, v255, v115, v116
    v_max3_u32 v255, v255, v117, v118
    v_max_u32 v255, v255, v119
    v_cmp_eq_u32 vcc, -1, v255
    s_nop 0
    s_cmp_lg_u64 vcc, 0
    s_cbranch_scc1 L_GCF_6_7
    v_mfma_f32_16x16x32_bf16 v[192:195], v[184:187], v[112:115], v[192:195]
    v_mfma_f32_16x16x32_bf16 v[200:203], v[188:191], v[112:115], v[200:203]
    v_mfma_f32_16x16x32_bf16 v[196:199], v[184:187], v[116:119], v[196:199]
    v_mfma_f32_16x16x32_bf16 v[204:207], v[188:191], v[116:119], v[204:207]
    s_bitset1_b32 s42, 7
L_GCF_6_7:
    s_add_u32 s53, s39, 114688
    buffer_load_dwordx4 v[168:171], v11, s[16:19], s53 offen sc1
    buffer_load_dwordx4 v[172:175], v11, s[16:19], s53 offen offset:2048 sc1
    s_waitcnt vmcnt(12)
    v_max3_u32 v255, v120, v121, v122
    v_max3_u32 v255, v255, v123, v124
    v_max3_u32 v255, v255, v125, v126
    v_max_u32 v255, v255, v127
    v_cmp_eq_u32 vcc, -1, v255
    s_nop 0
    s_cmp_lg_u64 vcc, 0
    s_cbranch_scc1 L_GCF_6_8
    v_mfma_f32_16x16x32_bf16 v[192:195], v[184:187], v[120:123], v[192:195]
    v_mfma_f32_16x16x32_bf16 v[200:203], v[188:191], v[120:123], v[200:203]
    v_mfma_f32_16x16x32_bf16 v[196:199], v[184:187], v[124:127], v[196:199]
    v_mfma_f32_16x16x32_bf16 v[204:207], v[188:191], v[124:127], v[204:207]
    s_bitset1_b32 s42, 8
L_GCF_6_8:
    s_add_u32 s53, s39, 122880
    buffer_load_dwordx4 v[176:179], v11, s[16:19], s53 offen sc1
    buffer_load_dwordx4 v[180:183], v11, s[16:19], s53 offen offset:2048 sc1
    s_waitcnt vmcnt(12)
    v_max3_u32 v255, v128, v129, v130
    v_max3_u32 v255, v255, v131, v132
    v_max3_u32 v255, v255, v133, v134
    v_max_u32 v255, v255, v135
    v_cmp_eq_u32 vcc, -1, v255
    s_nop 0
    s_cmp_lg_u64 vcc, 0
    s_cbranch_scc1 L_GCF_6_9
    v_mfma_f32_16x16x32_bf16 v[192:195], v[184:187], v[128:131], v[192:195]
    v_mfma_f32_16x16x32_bf16 v[200:203], v[188:191], v[128:131], v[200:203]
    v_mfma_f32_16x16x32_bf16 v[196:199], v[184:187], v[132:135], v[196:199]
    v_mfma_f32_16x16x32_bf16 v[204:207], v[188:191], v[132:135], v[204:207]
    s_bitset1_b32 s42, 9
L_GCF_6_9:
    s_waitcnt vmcnt(10)
    v_max3_u32 v255, v136, v137, v138
    v_max3_u32 v255, v255, v139, v140
    v_max3_u32 v255, v255, v141, v142
    v_max_u32 v255, v255, v143
    v_cmp_eq_u32 vcc, -1, v255
    s_nop 0
    s_cmp_lg_u64 vcc, 0
    s_cbranch_scc1 L_GCF_6_10
    v_mfma_f32_16x16x32_bf16 v[192:195], v[184:187], v[136:139], v[192:195]
    v_mfma_f32_16x16x32_bf16 v[200:203], v[188:191], v[136:139], v[200:203]
    v_mfma_f32_16x16x32_bf16 v[196:199], v[184:187], v[140:143], v[196:199]
    v_mfma_f32_16x16x32_bf16 v[204:207], v[188:191], v[140:143], v[204:207]
    s_bitset1_b32 s42, 10
L_GCF_6_10:
    s_waitcnt vmcnt(8)
    v_max3_u32 v255, v144, v145, v146
    v_max3_u32 v255, v255, v147, v148
    v_max3_u32 v255, v255, v149, v150
    v_max_u32 v255, v255, v151
    v_cmp_eq_u32 vcc, -1, v255
    s_nop 0
    s_cmp_lg_u64 vcc, 0
    s_cbranch_scc1 L_GCF_6_11
    v_mfma_f32_16x16x32_bf16 v[192:195], v[184:187], v[144:147], v[192:195]
    v_mfma_f32_16x16x32_bf16 v[200:203], v[188:191], v[144:147], v[200:203]
    v_mfma_f32_16x16x32_bf16 v[196:199], v[184:187], v[148:151], v[196:199]
    v_mfma_f32_16x16x32_bf16 v[204:207], v[188:191], v[148:151], v[204:207]
    s_bitset1_b32 s42, 11
L_GCF_6_11:
    s_waitcnt vmcnt(6)
    v_max3_u32 v255, v152, v153, v154
    v_max3_u32 v255, v255, v155, v156
    v_max3_u32 v255, v255, v157, v158
    v_max_u32 v255, v255, v159
    v_cmp_eq_u32 vcc, -1, v255
    s_nop 0
    s_cmp_lg_u64 vcc, 0
    s_cbranch_scc1 L_GCF_6_12
    v_mfma_f32_16x16x32_bf16 v[192:195], v[184:187], v[152:155], v[192:195]
    v_mfma_f32_16x16x32_bf16 v[200:203], v[188:191], v[152:155], v[200:203]
    v_mfma_f32_16x16x32_bf16 v[196:199], v[184:187], v[156:159], v[196:199]
    v_mfma_f32_16x16x32_bf16 v[204:207], v[188:191], v[156:159], v[204:207]
    s_bitset1_b32 s42, 12
L_GCF_6_12:
    s_waitcnt vmcnt(4)
    v_max3_u32 v255, v160, v161, v162
    v_max3_u32 v255, v255, v163, v164
    v_max3_u32 v255, v255, v165, v166
    v_max_u32 v255, v255, v167
    v_cmp_eq_u32 vcc, -1, v255
    s_nop 0
    s_cmp_lg_u64 vcc, 0
    s_cbranch_scc1 L_GCF_6_13
    v_mfma_f32_16x16x32_bf16 v[192:195], v[184:187], v[160:163], v[192:195]
    v_mfma_f32_16x16x32_bf16 v[200:203], v[188:191], v[160:163], v[200:203]
    v_mfma_f32_16x16x32_bf16 v[196:199], v[184:187], v[164:167], v[196:199]
    v_mfma_f32_16x16x32_bf16 v[204:207], v[188:191], v[164:167], v[204:207]
    s_bitset1_b32 s42, 13
L_GCF_6_13:
    s_waitcnt vmcnt(2)
    v_max3_u32 v255, v168, v169, v170
    v_max3_u32 v255, v255, v171, v172
    v_max3_u32 v255, v255, v173, v174
    v_max_u32 v255, v255, v175
    v_cmp_eq_u32 vcc, -1, v255
    s_nop 0
    s_cmp_lg_u64 vcc, 0
    s_cbranch_scc1 L_GCF_6_14
    v_mfma_f32_16x16x32_bf16 v[192:195], v[184:187], v[168:171], v[192:195]
    v_mfma_f32_16x16x32_bf16 v[200:203], v[188:191], v[168:171], v[200:203]
    v_mfma_f32_16x16x32_bf16 v[196:199], v[184:187], v[172:175], v[196:199]
    v_mfma_f32_16x16x32_bf16 v[204:207], v[188:191], v[172:175], v[204:207]
    s_bitset1_b32 s42, 14
L_GCF_6_14:
    s_waitcnt vmcnt(0)
    v_max3_u32 v255, v176, v177, v178
    v_max3_u32 v255, v255, v179, v180
    v_max3_u32 v255, v255, v181, v182
    v_max_u32 v255, v255, v183
    v_cmp_eq_u32 vcc, -1, v255
    s_nop 0
    s_cmp_lg_u64 vcc, 0
    s_cbranch_scc1 L_GCF_6_15
    v_mfma_f32_16x16x32_bf16 v[192:195], v[184:187], v[176:179], v[192:195]
    v_mfma_f32_16x16x32_bf16 v[200:203], v[188:191], v[176:179], v[200:203]
    v_mfma_f32_16x16x32_bf16 v[196:199], v[184:187], v[180:183], v[196:199]
    v_mfma_f32_16x16x32_bf16 v[204:207], v[188:191], v[180:183], v[204:207]
    s_bitset1_b32 s42, 15
L_GCF_6_15:
    s_branch L_GNC_6
L_GAX_6:
    s_nop 7
    v_cvt_pk_bf16_f32 v208, v192, v193
    v_cvt_pk_bf16_f32 v209, v194, v195
    v_cvt_pk_bf16_f32 v210, v196, v197
    v_cvt_pk_bf16_f32 v211, v198, v199
    v_min_u32 v208, 0xfffffffe, v208
    v_min_u32 v209, 0xfffffffe, v209
    v_min_u32 v210, 0xfffffffe, v210
    v_min_u32 v211, 0xfffffffe, v211
    buffer_store_dwordx4 v[208:211], v11, s[16:19], s40 offen offset:0 sc1
    v_cvt_pk_bf16_f32 v212, v200, v201
    v_cvt_pk_bf16_f32 v213, v202, v203
    v_cvt_pk_bf16_f32 v214, v204, v205
    v_cvt_pk_bf16_f32 v215, v206, v207
    v_min_u32 v212, 0xfffffffe, v212
    v_min_u32 v213, 0xfffffffe, v213
    v_min_u32 v214, 0xfffffffe, v214
    v_min_u32 v215, 0xfffffffe, v215
    buffer_store_dwordx4 v[212:215], v11, s[16:19], s40 offen offset:1024 sc1
    s_nop 1
    s_branch L_END
L_NORED:
    s_add_u32 m0, s44, 57344
    s_mov_b32 s5, 0
    buffer_load_dwordx4 v248, s[72:75], s5 offen lds
    s_add_u32 m0, s44, 58368
    s_mov_b32 s5, 7168
    buffer_load_dwordx4 v248, s[72:75], s5 offen lds
    s_add_u32 m0, s44, 59392
    s_mov_b32 s5, 14336
    buffer_load_dwordx4 v248, s[72:75], s5 offen lds
    s_add_u32 m0, s44, 60416
    s_mov_b32 s5, 21504
    buffer_load_dwordx4 v248, s[72:75], s5 offen lds
    s_add_u32 m0, s44, 61440
    s_mov_b32 s5, 28672
    buffer_load_dwordx4 v248, s[72:75], s5 offen lds
    s_add_u32 m0, s44, 62464
    s_mov_b32 s5, 35840
    buffer_load_dwordx4 v248, s[72:75], s5 offen lds
    s_add_u32 m0, s44, 63488
    s_mov_b32 s5, 43008
    buffer_load_dwordx4 v248, s[72:75], s5 offen lds
    s_add_u32 m0, s44, 0
    s_mov_b32 s5, 0
    buffer_load_dwordx4 v248, s[76:79], s5 offen lds
    s_add_u32 m0, s44, 1024
    s_mov_b32 s5, 7168
    buffer_load_dwordx4 v248, s[76:79], s5 offen lds
    s_add_u32 m0, s44, 2048
    s_mov_b32 s5, 14336
    buffer_load_dwordx4 v248, s[76:79], s5 offen lds
    s_add_u32 m0, s44, 3072
    s_mov_b32 s5, 21504
    buffer_load_dwordx4 v248, s[76:79], s5 offen lds
    s_add_u32 m0, s44, 4096
    s_mov_b32 s5, 28672
    buffer_load_dwordx4 v248, s[76:79], s5 offen lds
    s_add_u32 m0, s44, 5120
    s_mov_b32 s5, 35840
    buffer_load_dwordx4 v248, s[76:79], s5 offen lds
    s_add_u32 m0, s44, 6144
    s_mov_b32 s5, 43008
    buffer_load_dwordx4 v248, s[76:79], s5 offen lds
    s_waitcnt vmcnt(0)
L_P2:
    v_mov_b32 v24, 0
    v_mov_b32 v25, 0
    v_mov_b32 v26, 0
    v_mov_b32 v27, 0
    v_mov_b32 v28, 0
    v_mov_b32 v29, 0
    v_mov_b32 v30, 0
    v_mov_b32 v31, 0
    v_mov_b32 v32, 0
    v_mov_b32 v33, 0
    v_mov_b32 v34, 0
    v_mov_b32 v35, 0
    v_mov_b32 v36, 0
    v_mov_b32 v37, 0
    v_mov_b32 v38, 0
    v_mov_b32 v39, 0
    s_barrier
    s_mov_b32 s67, 0
L_P2_HALF:
    ds_read_b64_tr_b16 v[104:105], v16 offset:0
    ds_read_b64_tr_b16 v[106:107], v16 offset:2048
    ds_read_b64_tr_b16 v[108:109], v17 offset:0
    ds_read_b64_tr_b16 v[110:111], v17 offset:2048
    ds_read_b64_tr_b16 v[112:113], v18 offset:0
    ds_read_b64_tr_b16 v[114:115], v18 offset:2048
    ds_read_b64_tr_b16 v[116:117], v19 offset:0
    ds_read_b64_tr_b16 v[118:119], v19 offset:2048
    ds_read_b64_tr_b16 v[120:121], v20 offset:3584
    ds_read_b64_tr_b16 v[122:123], v20 offset:5632
    ds_read_b64_tr_b16 v[124:125], v21 offset:3584
    ds_read_b64_tr_b16 v[126:127], v21 offset:5632
    ds_read_b64_tr_b16 v[128:129], v22 offset:3584
    ds_read_b64_tr_b16 v[130:131], v22 offset:5632
    ds_read_b64_tr_b16 v[132:133], v23 offset:3584
    ds_read_b64_tr_b16 v[134:135], v23 offset:5632
    ds_read_b64_tr_b16 v[136:137], v16 offset:7168
    ds_read_b64_tr_b16 v[138:139], v16 offset:9216
    ds_read_b64_tr_b16 v[140:141], v17 offset:7168
    ds_read_b64_tr_b16 v[142:143], v17 offset:9216
    ds_read_b64_tr_b16 v[144:145], v18 offset:7168
    ds_read_b64_tr_b16 v[146:147], v18 offset:9216
    ds_read_b64_tr_b16 v[148:149], v19 offset:7168
    ds_read_b64_tr_b16 v[150:151], v19 offset:9216
    ds_read_b64_tr_b16 v[152:153], v20 offset:10752
    ds_read_b64_tr_b16 v[154:155], v20 offset:12800
    ds_read_b64_tr_b16 v[156:157], v21 offset:10752
    ds_read_b64_tr_b16 v[158:159], v21 offset:12800
    ds_read_b64_tr_b16 v[160:161], v22 offset:10752
    ds_read_b64_tr_b16 v[162:163], v22 offset:12800
    ds_read_b64_tr_b16 v[164:165], v23 offset:10752
    ds_read_b64_tr_b16 v[166:167], v23 offset:12800
    ds_read_b64_tr_b16 v[168:169], v16 offset:14336
    ds_read_b64_tr_b16 v[170:171], v16 offset:16384
    ds_read_b64_tr_b16 v[172:173], v17 offset:14336
    ds_read_b64_tr_b16 v[174:175], v17 offset:16384
    ds_read_b64_tr_b16 v[176:177], v18 offset:14336
    ds_read_b64_tr_b16 v[178:179], v18 offset:16384
    ds_read_b64_tr_b16 v[180:181], v19 offset:14336
    ds_read_b64_tr_b16 v[182:183], v19 offset:16384
    ds_read_b64_tr_b16 v[184:185], v20 offset:17920
    ds_read_b64_tr_b16 v[186:187], v20 offset:19968
    ds_read_b64_tr_b16 v[188:189], v21 offset:17920
    ds_read_b64_tr_b16 v[190:191], v21 offset:19968
    ds_read_b64_tr_b16 v[192:193], v22 offset:17920
    ds_read_b64_tr_b16 v[194:195], v22 offset:19968
    ds_read_b64_tr_b16 v[196:197], v23 offset:17920
    ds_read_b64_tr_b16 v[198:199], v23 offset:19968
    ds_read_b64_tr_b16 v[200:201], v16 offset:21504
    ds_read_b64_tr_b16 v[202:203], v16 offset:23552
    ds_read_b64_tr_b16 v[204:205], v17 offset:21504
    ds_read_b64_tr_b16 v[206:207], v17 offset:23552
    ds_read_b64_tr_b16 v[208:209], v18 offset:21504
    ds_read_b64_tr_b16 v[210:211], v18 offset:23552
    ds_read_b64_tr_b16 v[212:213], v19 offset:21504
    ds_read_b64_tr_b16 v[214:215], v19 offset:23552
    ds_read_b64_tr_b16 v[216:217], v20 offset:25088
    ds_read_b64_tr_b16 v[218:219], v20 offset:27136
    ds_read_b64_tr_b16 v[220:221], v21 offset:25088
    ds_read_b64_tr_b16 v[222:223], v21 offset:27136
    ds_read_b64_tr_b16 v[224:225], v22 offset:25088
    ds_read_b64_tr_b16 v[226:227], v22 offset:27136
    ds_read_b64_tr_b16 v[228:229], v23 offset:25088
    ds_read_b64_tr_b16 v[230:231], v23 offset:27136
    s_mov_b32 s3, 0
    s_mov_b32 s42, 0
    s_mov_b32 s43, 0
L_GA_7:
    s_andn2_b32 s7, s43, s42
    s_cmp_eq_u32 s7, 255
    s_cbranch_scc1 L_GF_7
    s_cmp_eq_u32 s43, 255
    s_cbranch_scc1 L_GNP_7
    buffer_load_dword v253, v7, s[16:19], s65 offen sc1
L_GNP_7:
    s_cmp_eq_u32 s7, 0
    s_cbranch_scc1 L_GNL_7
    s_bitcmp1_b32 s7, 0
    s_cbranch_scc0 L_GK_7_0
    s_add_u32 s53, s64, 0
    buffer_load_dwordx4 v[40:43], v11, s[16:19], s53 offen sc1
L_GK_7_0:
    s_bitcmp1_b32 s7, 1
    s_cbranch_scc0 L_GK_7_1
    s_add_u32 s53, s64, 1024
    buffer_load_dwordx4 v[44:47], v11, s[16:19], s53 offen sc1
L_GK_7_1:
    s_bitcmp1_b32 s7, 2
    s_cbranch_scc0 L_GK_7_2
    s_add_u32 s53, s64, 2048
    buffer_load_dwordx4 v[48:51], v11, s[16:19], s53 offen sc1
L_GK_7_2:
    s_bitcmp1_b32 s7, 3
    s_cbranch_scc0 L_GK_7_3
    s_add_u32 s53, s64, 3072
    buffer_load_dwordx4 v[52:55], v11, s[16:19], s53 offen sc1
L_GK_7_3:
    s_bitcmp1_b32 s7, 4
    s_cbranch_scc0 L_GK_7_4
    s_add_u32 s53, s64, 4096
    buffer_load_dwordx4 v[56:59], v11, s[16:19], s53 offen sc1
L_GK_7_4:
    s_bitcmp1_b32 s7, 5
    s_cbranch_scc0 L_GK_7_5
    s_add_u32 s53, s64, 5120
    buffer_load_dwordx4 v[60:63], v11, s[16:19], s53 offen sc1
L_GK_7_5:
    s_bitcmp1_b32 s7, 6
    s_cbranch_scc0 L_GK_7_6
    s_add_u32 s53, s64, 6144
    buffer_load_dwordx4 v[64:67], v11, s[16:19], s53 offen sc1
L_GK_7_6:
    s_bitcmp1_b32 s7, 7
    s_cbranch_scc0 L_GK_7_7
    s_add_u32 s53, s64, 7168
    buffer_load_dwordx4 v[68:71], v11, s[16:19], s53 offen sc1
L_GK_7_7:
L_GNL_7:
    s_waitcnt vmcnt(0)
    v_cmp_eq_u32 vcc, s49, v253
    s_nop 0
    s_lshr_b32 s4, vcc_lo, s66
    s_and_b32 s4, s4, 0xff
    s_waitcnt lgkmcnt(0)
    s_or_b32 s43, s43, s4
    s_cmp_eq_u32 s7, 0
    s_cbranch_scc1 L_GNC_7
    s_bitcmp1_b32 s7, 0
    s_cbranch_scc0 L_GCL_7_0
    v_max3_u32 v255, v40, v41, v42
    v_max_u32 v255, v255, v43
    v_cmp_eq_u32 vcc, -1, v255
    s_nop 0
    s_cmp_lg_u64 vcc, 0
    s_cbranch_scc1 L_GCL_7_0
    v_mfma_f32_16x16x32_bf16 v[24:27], v[104:107], v[40:43], v[24:27]
    v_mfma_f32_16x16x32_bf16 v[28:31], v[108:111], v[40:43], v[28:31]
    v_mfma_f32_16x16x32_bf16 v[32:35], v[112:115], v[40:43], v[32:35]
    v_mfma_f32_16x16x32_bf16 v[36:39], v[116:119], v[40:43], v[36:39]
    s_bitset1_b32 s42, 0
L_GCL_7_0:
    s_bitcmp1_b32 s7, 1
    s_cbranch_scc0 L_GCL_7_1
    v_max3_u32 v255, v44, v45, v46
    v_max_u32 v255, v255, v47
    v_cmp_eq_u32 vcc, -1, v255
    s_nop 0
    s_cmp_lg_u64 vcc, 0
    s_cbranch_scc1 L_GCL_7_1
    v_mfma_f32_16x16x32_bf16 v[24:27], v[120:123], v[44:47], v[24:27]
    v_mfma_f32_16x16x32_bf16 v[28:31], v[124:127], v[44:47], v[28:31]
    v_mfma_f32_16x16x32_bf16 v[32:35], v[128:131], v[44:47], v[32:35]
    v_mfma_f32_16x16x32_bf16 v[36:39], v[132:135], v[44:47], v[36:39]
    s_bitset1_b32 s42, 1
L_GCL_7_1:
    s_bitcmp1_b32 s7, 2
    s_cbranch_scc0 L_GCL_7_2
    v_max3_u32 v255, v48, v49, v50
    v_max_u32 v255, v255, v51
    v_cmp_eq_u32 vcc, -1, v255
    s_nop 0
    s_cmp_lg_u64 vcc, 0
    s_cbranch_scc1 L_GCL_7_2
    v_mfma_f32_16x16x32_bf16 v[24:27], v[136:139], v[48:51], v[24:27]
    v_mfma_f32_16x16x32_bf16 v[28:31], v[140:143], v[48:51], v[28:31]
    v_mfma_f32_16x16x32_bf16 v[32:35], v[144:147], v[48:51], v[32:35]
    v_mfma_f32_16x16x32_bf16 v[36:39], v[148:151], v[48:51], v[36:39]
    s_bitset1_b32 s42, 2
L_GCL_7_2:
    s_bitcmp1_b32 s7, 3
    s_cbranch_scc0 L_GCL_7_3
    v_max3_u32 v255, v52, v53, v54
    v_max_u32 v255, v255, v55
    v_cmp_eq_u32 vcc, -1, v255
    s_nop 0
    s_cmp_lg_u64 vcc, 0
    s_cbranch_scc1 L_GCL_7_3
    v_mfma_f32_16x16x32_bf16 v[24:27], v[152:155], v[52:55], v[24:27]
    v_mfma_f32_16x16x32_bf16 v[28:31], v[156:159], v[52:55], v[28:31]
    v_mfma_f32_16x16x32_bf16 v[32:35], v[160:163], v[52:55], v[32:35]
    v_mfma_f32_16x16x32_bf16 v[36:39], v[164:167], v[52:55], v[36:39]
    s_bitset1_b32 s42, 3
L_GCL_7_3:
    s_bitcmp1_b32 s7, 4
    s_cbranch_scc0 L_GCL_7_4
    v_max3_u32 v255, v56, v57, v58
    v_max_u32 v255, v255, v59
    v_cmp_eq_u32 vcc, -1, v255
    s_nop 0
    s_cmp_lg_u64 vcc, 0
    s_cbranch_scc1 L_GCL_7_4
    v_mfma_f32_16x16x32_bf16 v[24:27], v[168:171], v[56:59], v[24:27]
    v_mfma_f32_16x16x32_bf16 v[28:31], v[172:175], v[56:59], v[28:31]
    v_mfma_f32_16x16x32_bf16 v[32:35], v[176:179], v[56:59], v[32:35]
    v_mfma_f32_16x16x32_bf16 v[36:39], v[180:183], v[56:59], v[36:39]
    s_bitset1_b32 s42, 4
L_GCL_7_4:
    s_bitcmp1_b32 s7, 5
    s_cbranch_scc0 L_GCL_7_5
    v_max3_u32 v255, v60, v61, v62
    v_max_u32 v255, v255, v63
    v_cmp_eq_u32 vcc, -1, v255
    s_nop 0
    s_cmp_lg_u64 vcc, 0
    s_cbranch_scc1 L_GCL_7_5
    v_mfma_f32_16x16x32_bf16 v[24:27], v[184:187], v[60:63], v[24:27]
    v_mfma_f32_16x16x32_bf16 v[28:31], v[188:191], v[60:63], v[28:31]
    v_mfma_f32_16x16x32_bf16 v[32:35], v[192:195], v[60:63], v[32:35]
    v_mfma_f32_16x16x32_bf16 v[36:39], v[196:199], v[60:63], v[36:39]
    s_bitset1_b32 s42, 5
L_GCL_7_5:
    s_bitcmp1_b32 s7, 6
    s_cbranch_scc0 L_GCL_7_6
    v_max3_u32 v255, v64, v65, v66
    v_max_u32 v255, v255, v67
    v_cmp_eq_u32 vcc, -1, v255
    s_nop 0
    s_cmp_lg_u64 vcc, 0
    s_cbranch_scc1 L_GCL_7_6
    v_mfma_f32_16x16x32_bf16 v[24:27], v[200:203], v[64:67], v[24:27]
    v_mfma_f32_16x16x32_bf16 v[28:31], v[204:207], v[64:67], v[28:31]
    v_mfma_f32_16x16x32_bf16 v[32:35], v[208:211], v[64:67], v[32:35]
    v_mfma_f32_16x16x32_bf16 v[36:39], v[212:215], v[64:67], v[36:39]
    s_bitset1_b32 s42, 6
L_GCL_7_6:
    s_bitcmp1_b32 s7, 7
    s_cbranch_scc0 L_GCL_7_7
    v_max3_u32 v255, v68, v69, v70
    v_max_u32 v255, v255, v71
    v_cmp_eq_u32 vcc, -1, v255
    s_nop 0
    s_cmp_lg_u64 vcc, 0
    s_cbranch_scc1 L_GCL_7_7
    v_mfma_f32_16x16x32_bf16 v[24:27], v[216:219], v[68:71], v[24:27]
    v_mfma_f32_16x16x32_bf16 v[28:31], v[220:223], v[68:71], v[28:31]
    v_mfma_f32_16x16x32_bf16 v[32:35], v[224:227], v[68:71], v[32:35]
    v_mfma_f32_16x16x32_bf16 v[36:39], v[228:231], v[68:71], v[36:39]
    s_bitset1_b32 s42, 7
L_GCL_7_7:
L_GNC_7:
    s_cmp_eq_u32 s42, 255
    s_cbranch_scc1 L_GAX_7
    s_add_u32 s3, s3, 1
    s_cmp_lt_u32 s3, 200000
    s_cbranch_scc1 L_GA_7
    s_branch L_GAX_7
L_GF_7:
    s_add_u32 s53, s64, 0
    buffer_load_dwordx4 v[40:43], v11, s[16:19], s53 offen sc1
    s_add_u32 s53, s64, 1024
    buffer_load_dwordx4 v[44:47], v11, s[16:19], s53 offen sc1
    s_add_u32 s53, s64, 2048
    buffer_load_dwordx4 v[48:51], v11, s[16:19], s53 offen sc1
    s_add_u32 s53, s64, 3072
    buffer_load_dwordx4 v[52:55], v11, s[16:19], s53 offen sc1
    s_add_u32 s53, s64, 4096
    buffer_load_dwordx4 v[56:59], v11, s[16:19], s53 offen sc1
    s_add_u32 s53, s64, 5120
    buffer_load_dwordx4 v[60:63], v11, s[16:19], s53 offen sc1
    s_add_u32 s53, s64, 6144
    buffer_load_dwordx4 v[64:67], v11, s[16:19], s53 offen sc1
    s_waitcnt vmcnt(6)
    v_max3_u32 v255, v40, v41, v42
    v_max_u32 v255, v255, v43
    v_cmp_eq_u32 vcc, -1, v255
    s_nop 0
    s_cmp_lg_u64 vcc, 0
    s_cbranch_scc1 L_GCF_7_0
    v_mfma_f32_16x16x32_bf16 v[24:27], v[104:107], v[40:43], v[24:27]
    v_mfma_f32_16x16x32_bf16 v[28:31], v[108:111], v[40:43], v[28:31]
    v_mfma_f32_16x16x32_bf16 v[32:35], v[112:115], v[40:43], v[32:35]
    v_mfma_f32_16x16x32_bf16 v[36:39], v[116:119], v[40:43], v[36:39]
    s_bitset1_b32 s42, 0
L_GCF_7_0:
    s_add_u32 s53, s64, 7168
    buffer_load_dwordx4 v[68:71], v11, s[16:19], s53 offen sc1
    s_waitcnt vmcnt(6)
    v_max3_u32 v255, v44, v45, v46
    v_max_u32 v255, v255, v47
    v_cmp_eq_u32 vcc, -1, v255
    s_nop 0
    s_cmp_lg_u64 vcc, 0
    s_cbranch_scc1 L_GCF_7_1
    v_mfma_f32_16x16x32_bf16 v[24:27], v[120:123], v[44:47], v[24:27]
    v_mfma_f32_16x16x32_bf16 v[28:31], v[124:127], v[44:47], v[28:31]
    v_mfma_f32_16x16x32_bf16 v[32:35], v[128:131], v[44:47], v[32:35]
    v_mfma_f32_16x16x32_bf16 v[36:39], v[132:135], v[44:47], v[36:39]
    s_bitset1_b32 s42, 1
L_GCF_7_1:
    s_waitcnt vmcnt(5)
    v_max3_u32 v255, v48, v49, v50
    v_max_u32 v255, v255, v51
    v_cmp_eq_u32 vcc, -1, v255
    s_nop 0
    s_cmp_lg_u64 vcc, 0
    s_cbranch_scc1 L_GCF_7_2
    v_mfma_f32_16x16x32_bf16 v[24:27], v[136:139], v[48:51], v[24:27]
    v_mfma_f32_16x16x32_bf16 v[28:31], v[140:143], v[48:51], v[28:31]
    v_mfma_f32_16x16x32_bf16 v[32:35], v[144:147], v[48:51], v[32:35]
    v_mfma_f32_16x16x32_bf16 v[36:39], v[148:151], v[48:51], v[36:39]
    s_bitset1_b32 s42, 2
L_GCF_7_2:
    s_waitcnt vmcnt(4)
    v_max3_u32 v255, v52, v53, v54
    v_max_u32 v255, v255, v55
    v_cmp_eq_u32 vcc, -1, v255
    s_nop 0
    s_cmp_lg_u64 vcc, 0
    s_cbranch_scc1 L_GCF_7_3
    v_mfma_f32_16x16x32_bf16 v[24:27], v[152:155], v[52:55], v[24:27]
    v_mfma_f32_16x16x32_bf16 v[28:31], v[156:159], v[52:55], v[28:31]
    v_mfma_f32_16x16x32_bf16 v[32:35], v[160:163], v[52:55], v[32:35]
    v_mfma_f32_16x16x32_bf16 v[36:39], v[164:167], v[52:55], v[36:39]
    s_bitset1_b32 s42, 3
L_GCF_7_3:
    s_waitcnt vmcnt(3)
    v_max3_u32 v255, v56, v57, v58
    v_max_u32 v255, v255, v59
    v_cmp_eq_u32 vcc, -1, v255
    s_nop 0
    s_cmp_lg_u64 vcc, 0
    s_cbranch_scc1 L_GCF_7_4
    v_mfma_f32_16x16x32_bf16 v[24:27], v[168:171], v[56:59], v[24:27]
    v_mfma_f32_16x16x32_bf16 v[28:31], v[172:175], v[56:59], v[28:31]
    v_mfma_f32_16x16x32_bf16 v[32:35], v[176:179], v[56:59], v[32:35]
    v_mfma_f32_16x16x32_bf16 v[36:39], v[180:183], v[56:59], v[36:39]
    s_bitset1_b32 s42, 4
L_GCF_7_4:
    s_waitcnt vmcnt(2)
    v_max3_u32 v255, v60, v61, v62
    v_max_u32 v255, v255, v63
    v_cmp_eq_u32 vcc, -1, v255
    s_nop 0
    s_cmp_lg_u64 vcc, 0
    s_cbranch_scc1 L_GCF_7_5
    v_mfma_f32_16x16x32_bf16 v[24:27], v[184:187], v[60:63], v[24:27]
    v_mfma_f32_16x16x32_bf16 v[28:31], v[188:191], v[60:63], v[28:31]
    v_mfma_f32_16x16x32_bf16 v[32:35], v[192:195], v[60:63], v[32:35]
    v_mfma_f32_16x16x32_bf16 v[36:39], v[196:199], v[60:63], v[36:39]
    s_bitset1_b32 s42, 5
L_GCF_7_5:
    s_waitcnt vmcnt(1)
    v_max3_u32 v255, v64, v65, v66
    v_max_u32 v255, v255, v67
    v_cmp_eq_u32 vcc, -1, v255
    s_nop 0
    s_cmp_lg_u64 vcc, 0
    s_cbranch_scc1 L_GCF_7_6
    v_mfma_f32_16x16x32_bf16 v[24:27], v[200:203], v[64:67], v[24:27]
    v_mfma_f32_16x16x32_bf16 v[28:31], v[204:207], v[64:67], v[28:31]
    v_mfma_f32_16x16x32_bf16 v[32:35], v[208:211], v[64:67], v[32:35]
    v_mfma_f32_16x16x32_bf16 v[36:39], v[212:215], v[64:67], v[36:39]
    s_bitset1_b32 s42, 6
L_GCF_7_6:
    s_waitcnt vmcnt(0)
    v_max3_u32 v255, v68, v69, v70
    v_max_u32 v255, v255, v71
    v_cmp_eq_u32 vcc, -1, v255
    s_nop 0
    s_cmp_lg_u64 vcc, 0
    s_cbranch_scc1 L_GCF_7_7
    v_mfma_f32_16x16x32_bf16 v[24:27], v[216:219], v[68:71], v[24:27]
    v_mfma_f32_16x16x32_bf16 v[28:31], v[220:223], v[68:71], v[28:31]
    v_mfma_f32_16x16x32_bf16 v[32:35], v[224:227], v[68:71], v[32:35]
    v_mfma_f32_16x16x32_bf16 v[36:39], v[228:231], v[68:71], v[36:39]
    s_bitset1_b32 s42, 7
L_GCF_7_7:
    s_branch L_GNC_7
L_GAX_7:
    s_nop 7
    s_cmp_eq_u32 s67, 1
    s_cbranch_scc1 L_P2_FIN
    s_mov_b32 s67, 1
    v_subrev_u32 v16, 57344, v16
    v_subrev_u32 v17, 57344, v17
    v_subrev_u32 v18, 57344, v18
    v_subrev_u32 v19, 57344, v19
    v_subrev_u32 v20, 57344, v20
    v_subrev_u32 v21, 57344, v21
    v_subrev_u32 v22, 57344, v22
    v_subrev_u32 v23, 57344, v23
    s_add_u32 s65, s65, 16384
    s_add_u32 s64, s64, 2097152
    s_lshl_b32 s53, s54, 12
    s_add_u32 s53, s53, 131072
    v_add_u32 v3, s53, v11
    s_lshl_b32 s62, s46, 7
    s_add_u32 s62, s62, s55
    s_lshl_b32 s53, s54, 5
    s_add_u32 s62, s62, s53
    s_mul_i32 s62, s62, 896
    s_lshl_b32 s53, s47, 7
    s_add_u32 s62, s62, s53
    s_lshl_b32 s53, s52, 6
    s_add_u32 s62, s62, s53
    v_mul_u32_u24 v5, 1792, v1
    v_lshl_add_u32 v5, v2, 3, v5
    s_nop 1
    s_branch L_P2_HALF
L_P2_FIN:
    s_cmp_eq_u32 s52, 0
    s_cbranch_scc1 L_P2_K0
    ds_write_b128 v3, v[24:27] offset:0
    ds_write_b128 v3, v[28:31] offset:1024
    s_waitcnt lgkmcnt(0)
    s_barrier
    ds_read_b128 v[40:43], v3 offset:2048
    ds_read_b128 v[44:47], v3 offset:3072
    v_mov_b32 v24, v32
    v_mov_b32 v25, v33
    v_mov_b32 v26, v34
    v_mov_b32 v27, v35
    v_mov_b32 v28, v36
    v_mov_b32 v29, v37
    v_mov_b32 v30, v38
    v_mov_b32 v31, v39
    s_nop 1
    s_branch L_P2_ST
L_P2_K0:
    ds_write_b128 v3, v[32:35] offset:2048
    ds_write_b128 v3, v[36:39] offset:3072
    s_waitcnt lgkmcnt(0)
    s_barrier
    ds_read_b128 v[40:43], v3 offset:0
    ds_read_b128 v[44:47], v3 offset:1024
L_P2_ST:
    s_waitcnt lgkmcnt(1)
    v_pk_add_f32 v[24:25], v[24:25], v[40:41]
    v_pk_add_f32 v[26:27], v[26:27], v[42:43]
    v_cvt_pk_bf16_f32 v56, v24, v25
    v_cvt_pk_bf16_f32 v57, v26, v27
    buffer_store_dwordx2 v[56:57], v5, s[80:83], s62 offen offset:0
    s_waitcnt lgkmcnt(0)
    v_pk_add_f32 v[28:29], v[28:29], v[44:45]
    v_pk_add_f32 v[30:31], v[30:31], v[46:47]
    v_cvt_pk_bf16_f32 v58, v28, v29
    v_cvt_pk_bf16_f32 v59, v30, v31
    buffer_store_dwordx2 v[58:59], v5, s[80:83], s62 offen offset:32
    s_nop 0
L_END:
L_EXIT:
    s_endpgm
.section .rodata,"a"
.p2align 6
.amdhsa_kernel gated_mix__sliding_local_dilated__linear_kernel_hedgehog__prompt_kernel
  .amdhsa_next_free_vgpr 256
  .amdhsa_next_free_sgpr 102
  .amdhsa_accum_offset 256
  .amdhsa_group_segment_fixed_size 0
  .amdhsa_kernarg_size 88
  .amdhsa_user_sgpr_count 2
  .amdhsa_user_sgpr_kernarg_segment_ptr 1
  .amdhsa_system_sgpr_workgroup_id_x 1
.end_amdhsa_kernel
```
